```python
import torch

def _softmax(x, axis=-1):
    return torch.softmax(x, dim=axis)
def _gelu(x):
    return torch.nn.functional.gelu(x, approximate="tanh")
def _silu(x):
    return torch.nn.functional.silu(x)
def _sigmoid(x):
    return torch.sigmoid(x)
def _layernorm(x, axis=-1, eps=1e-5):
    m = x.mean(dim=axis, keepdim=True)
    v = x.var(dim=axis, keepdim=True, unbiased=False)
    return (x - m) / torch.sqrt(v + eps)
def _scatter_add(tgt, idx, src, axis=0):
    return tgt.clone().index_add_(axis, idx, src)
def _segment_sum(src, seg, n):
    out = torch.zeros((n,) + src.shape[1:], dtype=src.dtype)
    return out.index_add_(0, seg, src)
def _pad(x, pw):
    flat = tuple(v for pair in reversed(pw) for v in pair)
    return torch.nn.functional.pad(x, flat)

kernel_name = 'gated_mix__sliding_block__linear_attn_block__prompt'

def setup_inputs():

    _w = (lambda a: (lambda t: t.to(torch.bfloat16) if t.is_floating_point() else t)(torch.as_tensor(a)))
    def _A_setup():
        B, S, D = 1, 2048, 640
        return {
            "x": _w((lambda *s: torch.randn(*s, dtype=torch.bfloat16) * 0.05)(B, S, D)),
            "wqkv": _w((lambda *s: torch.randn(*s, dtype=torch.bfloat16) * 0.8)(D, 3 * D)),
            "wo": _w((lambda *s: torch.randn(*s, dtype=torch.bfloat16) * 0.05)(D, D)),
        }
    _A_in = _A_setup()

    def _B_setup():
        B, S, D = 1, 2048, 640
        return {
            "x": _w((lambda *s: torch.randn(*s, dtype=torch.bfloat16) * 0.05)(B, S, D)),
            "wqkv": _w((lambda *s: torch.randn(*s, dtype=torch.bfloat16) * 1.6)(D, 3 * D)),
            "wo": _w((lambda *s: torch.randn(*s, dtype=torch.bfloat16) * 0.4)(D, D)),
        }
    _B_in = _B_setup()

    return {
        "A_x": _A_in["x"],
        "A_wqkv": _A_in["wqkv"],
        "A_wo": _A_in["wo"],
        "B_x": _B_in["x"],
        "B_wqkv": _B_in["wqkv"],
        "B_wo": _B_in["wo"],
        "gate_w": _w((lambda *s: torch.randn(*s, dtype=torch.bfloat16) * 0.05)(640) * 16.0),
    }

def reference(A_x, A_wqkv, A_wo, B_x, B_wqkv, B_wo, gate_w):
    def _A_ref(x, wqkv, wo):
        B, S, D = x.shape
        H = 32; Dh = D // H; W = 256
        qkv = (lambda x, *d: x.permute(*d))((x @ wqkv).reshape(B, S, 3, H, Dh), 2, 0, 3, 1, 4)
        q, k, v = qkv[0], qkv[1], qkv[2]
        scores = torch.einsum("bhqd,bhkd->bhqk", q, k) * (Dh ** -0.5)
        idx = torch.arange(S)
        mask = (idx[:, None] - idx[None, :] >= 0) & (idx[:, None] - idx[None, :] < W)
        scores = torch.where(mask[None, None], scores, -1e9)
        p = _softmax(scores, axis=-1)
        o = torch.einsum("bhqk,bhkd->bhqd", p, v)
        return (lambda x, *d: x.permute(*d))(o, 0, 2, 1, 3).reshape(B, S, D) @ wo

    def _B_ref(x, wqkv, wo):
        B, S, D = x.shape
        H = 32; Dh = D // H
        qkv = (lambda x, *d: x.permute(*d))((x @ wqkv).reshape(B, S, 3, H, Dh), 2, 0, 3, 1, 4)
        q, k, v = qkv[0], qkv[1], qkv[2]
        phi = lambda t: torch.where(t > 0, t + 1, torch.exp(t)) + 1e-6
        pq, pk = phi(q), phi(k)
        kv = torch.einsum("bhsd,bhse->bhde", pk, v)
        z = torch.einsum("bhsd->bhd", pk)
        num = torch.einsum("bhqd,bhde->bhqe", pq, kv)
        den = torch.einsum("bhqd,bhd->bhq", pq, z)[..., None] + 1e-6
        o = num / den
        return (lambda x, *d: x.permute(*d))(o, 0, 2, 1, 3).reshape(B, S, D) @ wo

    x = A_x
    g = _sigmoid((x * gate_w).sum(-1, keepdims=True))
    a = _A_ref(x, A_wqkv, A_wo)
    b = _B_ref(x, B_wqkv, B_wo)
    return g * a + (1 - g) * b
```

```asm
; @launch grid=(256,1,1) block=(512,1,1) lds=163840
.amdgcn_target "amdgcn-amd-amdhsa--gfx950"
.text
.globl gated_mix__sliding_block__linear_attn_block__prompt_kernel
.p2align 8
.type gated_mix__sliding_block__linear_attn_block__prompt_kernel,@function
gated_mix__sliding_block__linear_attn_block__prompt_kernel:
    s_cmp_ge_u32 s2, 256
    s_cbranch_scc1 K_END
    s_load_dwordx16 s[4:19], s[0:1], 0
    s_load_dwordx4 s[20:23], s[0:1], 64
    v_lshrrev_b32 v1, 6, v0
    v_and_b32 v2, 63, v0
    v_readfirstlane_b32 s24, v1
    s_mov_b32 s98, 0
    s_and_b32 s25, s2, 7
    s_lshr_b32 s26, s2, 3
    s_and_b32 s27, s25, 3
    s_lshl_b32 s27, s27, 2
    s_and_b32 s28, s26, 3
    s_add_u32 s27, s27, s28
    s_lshr_b32 s28, s25, 2
    s_lshl_b32 s28, s28, 3
    s_lshr_b32 s29, s26, 2
    s_add_u32 s28, s28, s29
    s_lshr_b32 s29, s27, 3
    s_and_b32 s30, s27, 7
    s_mov_b32 s30, s25
    s_and_b32 s29, s26, 1
    s_lshr_b32 s28, s26, 1
    s_lshl_b32 s27, s29, 3
    s_add_u32 s27, s27, s30
    s_and_b32 s3, s26, 0
    s_mul_i32 s3, s3, 1
    s_lshr_b32 s26, s26, 2
    s_and_b32 s26, s26, 15
    s_mul_i32 s26, s26, 1
    s_add_u32 s3, s3, s26
    s_cmp_ge_u32 s3, 10
    s_cselect_b32 s26, 10, 0
    s_sub_u32 s3, s3, s26
    s_cmp_ge_u32 s3, 10
    s_cselect_b32 s26, 10, 0
    s_sub_u32 s3, s3, s26
    s_cmp_ge_u32 s3, 10
    s_cselect_b32 s26, 10, 0
    s_sub_u32 s3, s3, s26
    s_and_b32 s3, s28, 15
    s_mul_i32 s3, s3, 1
    s_mul_i32 s26, s30, 1
    s_add_u32 s3, s3, s26
    s_mul_i32 s26, s29, 0
    s_add_u32 s3, s3, s26
    s_mul_i32 s26, s3, 6554
    s_lshr_b32 s26, s26, 16
    s_mul_i32 s26, s26, 10
    s_sub_u32 s3, s3, s26
    s_mov_b32 s99, 17375232
    s_cmp_ge_u32 s24, 4
    s_cbranch_scc0 P1_CONS
    s_sub_u32 s31, s24, 4
    v_lshrrev_b32 v3, 3, v2
    v_and_b32 v4, 7, v2
    v_lshrrev_b32 v5, 1, v3
    v_xor_b32 v4, v4, v5
    v_lshlrev_b32 v4, 4, v4
    v_mul_u32_u24 v3, 1280, v3
    v_add_u32 v10, v3, v4
    v_xor_b32 v11, 64, v10
    v_add_u32 v11, 10240, v11
    v_add_u32 v12, 20480, v10
    v_add_u32 v13, 20480, v11
    v_cmp_lt_u32 vcc, 29, v2
    s_lshl_b32 s32, s28, 7
    s_lshl_b32 s33, s31, 5
    v_cndmask_b32 v3, 0, 1, vcc
    v_mul_u32_u24 v4, 30, v3
    v_sub_u32 v4, v2, v4
    v_mul_u32_u24 v5, 26, v4
    v_lshrrev_b32 v5, 8, v5
    v_mul_u32_u24 v6, 10, v5
    v_sub_u32 v6, v4, v6
    v_mul_u32_u24 v3, 3840, v3
    v_mul_u32_u24 v5, 1280, v5
    v_lshlrev_b32 v6, 4, v6
    v_add3_u32 v14, v3, v5, v6
    v_add_u32 v15, 7680, v14
    v_add_u32 v16, 30720, v14
    v_add_u32 v17, 38400, v14
    v_lshlrev_b32 v23, 4, v2
    s_add_u32 s32, s32, s33
    s_mul_i32 s32, s32, 1280
    s_and_b32 s33, s31, 1
    s_lshl_b32 s33, s33, 2
    s_lshr_b32 s34, s31, 1
    s_lshl_b32 s34, s34, 4
    s_add_u32 s33, s33, s34
    s_mul_i32 s33, s33, 3840
    s_mul_i32 s34, s30, 160
    s_add_u32 s33, s33, s34
    s_lshl_b32 s34, s31, 12
    s_mul_i32 s35, s31, 3840
    s_add_u32 s35, s35, 16384
    s_mov_b32 s48, -1
    s_mov_b32 s49, 0x0fffffff
    s_lshl_b32 s50, s31, 2
    s_add_u32 s50, s50, 151552
    v_mov_b32 v20, s50
    v_mov_b32 v21, 151568
    s_mov_b32 s52, 0
    s_lshl_b32 s56, s3, 7
    s_add_u32 s32, s32, s56
    s_mul_i32 s56, s3, 245760
    s_add_u32 s33, s33, s56
    s_sub_u32 s54, 10, s3
    s_lshl_b32 s55, s54, 1
    s_waitcnt lgkmcnt(0)
    s_mov_b32 s40, s4
    s_and_b32 s41, s5, 0xffff
    s_mov_b32 s42, 2621440
    s_mov_b32 s43, 0x00020000
    s_cmp_eq_u32 s29, 0
    s_cselect_b32 s44, s6, s12
    s_cselect_b32 s45, s7, s13
    s_and_b32 s45, s45, 0xffff
    s_mov_b32 s46, 2457600
    s_mov_b32 s47, 0x00020000
    s_cmp_lg_u32 s31, 0
    s_cbranch_scc1 P1_L_NOGATE
    s_mov_b32 s60, s16
    s_and_b32 s61, s17, 0xffff
    s_mov_b32 s62, 1280
    s_mov_b32 s63, 0x00020000
    s_mov_b32 m0, 141312
    s_mov_b32 s59, 1024
    buffer_load_dwordx4 v23, s[60:63], 0 offen lds
    s_mov_b32 m0, 142336
    s_nop 0
    buffer_load_dwordx4 v23, s[60:63], s59 offen lds
P1_L_NOGATE:
    s_mov_b32 s50, 0
    s_add_u32 s51, s50, s34
    s_add_u32 m0, s51, 0
    s_nop 0
    buffer_load_dwordx4 v10, s[40:43], s32 offen lds
    s_add_u32 m0, s51, 1024
    s_nop 0
    buffer_load_dwordx4 v11, s[40:43], s32 offen lds
    s_add_u32 m0, s51, 2048
    s_nop 0
    buffer_load_dwordx4 v12, s[40:43], s32 offen lds
    s_add_u32 m0, s51, 3072
    s_nop 0
    buffer_load_dwordx4 v13, s[40:43], s32 offen lds
    s_add_u32 s32, s32, 128
    s_sub_u32 s54, s54, 1
    s_cmp_eq_u32 s54, 0
    s_cselect_b32 s56, 1280, 0
    s_sub_u32 s32, s32, s56
    s_add_u32 s52, s52, 4
    s_add_u32 s51, s50, s35
    s_mov_b64 exec, s[48:49]
    s_add_u32 m0, s51, 0
    s_nop 0
    buffer_load_dwordx4 v14, s[44:47], s33 offen lds
    s_add_u32 m0, s51, 960
    s_nop 0
    buffer_load_dwordx4 v15, s[44:47], s33 offen lds
    s_add_u32 m0, s51, 1920
    s_nop 0
    buffer_load_dwordx4 v16, s[44:47], s33 offen lds
    s_add_u32 m0, s51, 2880
    s_nop 0
    buffer_load_dwordx4 v17, s[44:47], s33 offen lds
    s_mov_b64 exec, -1
    s_add_u32 s33, s33, 122880
    s_sub_u32 s55, s55, 1
    s_cmp_eq_u32 s55, 0
    s_cselect_b32 s56, 2457600, 0
    s_sub_u32 s33, s33, s56
    s_add_u32 s52, s52, 4
    s_mov_b32 s36, s22
    s_and_b32 s37, s23, 0xffff
    s_mov_b32 s38, 268435456
    s_mov_b32 s39, 0x00020000
    s_barrier
    s_add_u32 s51, s50, s35
    s_mov_b64 exec, s[48:49]
    s_add_u32 m0, s51, 15360
    s_nop 0
    buffer_load_dwordx4 v14, s[44:47], s33 offen lds
    s_add_u32 m0, s51, 16320
    s_nop 0
    buffer_load_dwordx4 v15, s[44:47], s33 offen lds
    s_add_u32 m0, s51, 17280
    s_nop 0
    buffer_load_dwordx4 v16, s[44:47], s33 offen lds
    s_add_u32 m0, s51, 18240
    s_nop 0
    buffer_load_dwordx4 v17, s[44:47], s33 offen lds
    s_mov_b64 exec, -1
    s_add_u32 s33, s33, 122880
    s_sub_u32 s55, s55, 1
    s_cmp_eq_u32 s55, 0
    s_cselect_b32 s56, 2457600, 0
    s_sub_u32 s33, s33, s56
    s_add_u32 s52, s52, 4
    s_getreg_b32 s56, hwreg(HW_REG_IB_STS)
    s_lshr_b32 s57, s56, 18
    s_and_b32 s57, s57, 0x30
    s_and_b32 s56, s56, 15
    s_or_b32 s56, s56, s57
    s_sub_i32 s56, s52, s56
    s_max_i32 s56, s56, 0
    s_lshr_b32 s56, s56, 2
    v_mov_b32 v22, s56
    ds_write_b32 v20, v22
    s_mov_b32 s50, 47104
    s_mov_b32 s53, -3
P1_L_LOOP:
P1_L_G1_T:
    ds_read_b128 v[24:27], v21
    s_waitcnt lgkmcnt(0)
    v_min3_u32 v24, v24, v25, v26
    v_min_u32 v24, v24, v27
    s_nop 0
    v_readfirstlane_b32 s58, v24
    s_nop 1
    s_cmp_ge_i32 s58, s53
    s_cbranch_scc1 P1_L_G1
    s_getreg_b32 s56, hwreg(HW_REG_IB_STS)
    s_lshr_b32 s57, s56, 18
    s_and_b32 s57, s57, 0x30
    s_and_b32 s56, s56, 15
    s_or_b32 s56, s56, s57
    s_sub_i32 s56, s52, s56
    s_max_i32 s56, s56, 0
    s_lshr_b32 s56, s56, 2
    v_mov_b32 v22, s56
    ds_write_b32 v20, v22
    s_sleep 2
    s_add_u32 s98, s98, 1
    s_cmp_gt_u32 s98, 524288
    s_cbranch_scc0 P1_L_G1_T
P1_L_G1:
    s_add_u32 s51, s50, s35
    s_mov_b64 exec, s[48:49]
    s_add_u32 m0, s51, 0
    s_nop 0
    buffer_load_dwordx4 v14, s[44:47], s33 offen lds
    s_add_u32 m0, s51, 960
    s_nop 0
    buffer_load_dwordx4 v15, s[44:47], s33 offen lds
    s_add_u32 m0, s51, 1920
    s_nop 0
    buffer_load_dwordx4 v16, s[44:47], s33 offen lds
    s_add_u32 m0, s51, 2880
    s_nop 0
    buffer_load_dwordx4 v17, s[44:47], s33 offen lds
    s_mov_b64 exec, -1
    s_add_u32 s33, s33, 122880
    s_sub_u32 s55, s55, 1
    s_cmp_eq_u32 s55, 0
    s_cselect_b32 s56, 2457600, 0
    s_sub_u32 s33, s33, s56
    s_add_u32 s52, s52, 4
    s_getreg_b32 s56, hwreg(HW_REG_IB_STS)
    s_lshr_b32 s57, s56, 18
    s_and_b32 s57, s57, 0x30
    s_and_b32 s56, s56, 15
    s_or_b32 s56, s56, s57
    s_sub_i32 s56, s52, s56
    s_max_i32 s56, s56, 0
    s_lshr_b32 s56, s56, 2
    v_mov_b32 v22, s56
    ds_write_b32 v20, v22
    s_add_u32 s53, s53, 1
P1_L_G2_T:
    ds_read_b128 v[24:27], v21
    s_waitcnt lgkmcnt(0)
    v_min3_u32 v24, v24, v25, v26
    v_min_u32 v24, v24, v27
    s_nop 0
    v_readfirstlane_b32 s58, v24
    s_nop 1
    s_cmp_ge_i32 s58, s53
    s_cbranch_scc1 P1_L_G2
    s_getreg_b32 s56, hwreg(HW_REG_IB_STS)
    s_lshr_b32 s57, s56, 18
    s_and_b32 s57, s57, 0x30
    s_and_b32 s56, s56, 15
    s_or_b32 s56, s56, s57
    s_sub_i32 s56, s52, s56
    s_max_i32 s56, s56, 0
    s_lshr_b32 s56, s56, 2
    v_mov_b32 v22, s56
    ds_write_b32 v20, v22
    s_sleep 2
    s_add_u32 s98, s98, 1
    s_cmp_gt_u32 s98, 524288
    s_cbranch_scc0 P1_L_G2_T
P1_L_G2:
    s_add_u32 s51, s50, s34
    s_add_u32 m0, s51, 0
    s_nop 0
    buffer_load_dwordx4 v10, s[40:43], s32 offen lds
    s_add_u32 m0, s51, 1024
    s_nop 0
    buffer_load_dwordx4 v11, s[40:43], s32 offen lds
    s_add_u32 m0, s51, 2048
    s_nop 0
    buffer_load_dwordx4 v12, s[40:43], s32 offen lds
    s_add_u32 m0, s51, 3072
    s_nop 0
    buffer_load_dwordx4 v13, s[40:43], s32 offen lds
    s_add_u32 s32, s32, 128
    s_sub_u32 s54, s54, 1
    s_cmp_eq_u32 s54, 0
    s_cselect_b32 s56, 1280, 0
    s_sub_u32 s32, s32, s56
    s_add_u32 s52, s52, 4
    s_getreg_b32 s56, hwreg(HW_REG_IB_STS)
    s_lshr_b32 s57, s56, 18
    s_and_b32 s57, s57, 0x30
    s_and_b32 s56, s56, 15
    s_or_b32 s56, s56, s57
    s_sub_i32 s56, s52, s56
    s_max_i32 s56, s56, 0
    s_lshr_b32 s56, s56, 2
    v_mov_b32 v22, s56
    ds_write_b32 v20, v22
    s_add_u32 s51, s50, s35
    s_mov_b64 exec, s[48:49]
    s_add_u32 m0, s51, 15360
    s_nop 0
    buffer_load_dwordx4 v14, s[44:47], s33 offen lds
    s_add_u32 m0, s51, 16320
    s_nop 0
    buffer_load_dwordx4 v15, s[44:47], s33 offen lds
    s_add_u32 m0, s51, 17280
    s_nop 0
    buffer_load_dwordx4 v16, s[44:47], s33 offen lds
    s_add_u32 m0, s51, 18240
    s_nop 0
    buffer_load_dwordx4 v17, s[44:47], s33 offen lds
    s_mov_b64 exec, -1
    s_add_u32 s33, s33, 122880
    s_sub_u32 s55, s55, 1
    s_cmp_eq_u32 s55, 0
    s_cselect_b32 s56, 2457600, 0
    s_sub_u32 s33, s33, s56
    s_add_u32 s52, s52, 4
    s_getreg_b32 s56, hwreg(HW_REG_IB_STS)
    s_lshr_b32 s57, s56, 18
    s_and_b32 s57, s57, 0x30
    s_and_b32 s56, s56, 15
    s_or_b32 s56, s56, s57
    s_sub_i32 s56, s52, s56
    s_max_i32 s56, s56, 0
    s_lshr_b32 s56, s56, 2
    v_mov_b32 v22, s56
    ds_write_b32 v20, v22
    s_add_u32 s53, s53, 1
    s_add_u32 s50, s50, 47104
    s_cmp_eq_u32 s50, 141312
    s_cselect_b32 s50, 0, s50
    s_cmp_lt_i32 s53, 15
    s_cbranch_scc1 P1_L_LOOP
    s_waitcnt vmcnt(12)
    s_getreg_b32 s56, hwreg(HW_REG_IB_STS)
    s_lshr_b32 s57, s56, 18
    s_and_b32 s57, s57, 0x30
    s_and_b32 s56, s56, 15
    s_or_b32 s56, s56, s57
    s_sub_i32 s56, s52, s56
    s_max_i32 s56, s56, 0
    s_lshr_b32 s56, s56, 2
    v_mov_b32 v22, s56
    ds_write_b32 v20, v22
    s_waitcnt vmcnt(8)
    s_getreg_b32 s56, hwreg(HW_REG_IB_STS)
    s_lshr_b32 s57, s56, 18
    s_and_b32 s57, s57, 0x30
    s_and_b32 s56, s56, 15
    s_or_b32 s56, s56, s57
    s_sub_i32 s56, s52, s56
    s_max_i32 s56, s56, 0
    s_lshr_b32 s56, s56, 2
    v_mov_b32 v22, s56
    ds_write_b32 v20, v22
    s_waitcnt vmcnt(4)
    s_getreg_b32 s56, hwreg(HW_REG_IB_STS)
    s_lshr_b32 s57, s56, 18
    s_and_b32 s57, s57, 0x30
    s_and_b32 s56, s56, 15
    s_or_b32 s56, s56, s57
    s_sub_i32 s56, s52, s56
    s_max_i32 s56, s56, 0
    s_lshr_b32 s56, s56, 2
    v_mov_b32 v22, s56
    ds_write_b32 v20, v22
    s_waitcnt vmcnt(0)
    s_getreg_b32 s56, hwreg(HW_REG_IB_STS)
    s_lshr_b32 s57, s56, 18
    s_and_b32 s57, s57, 0x30
    s_and_b32 s56, s56, 15
    s_or_b32 s56, s56, s57
    s_sub_i32 s56, s52, s56
    s_max_i32 s56, s56, 0
    s_lshr_b32 s56, s56, 2
    v_mov_b32 v22, s56
    ds_write_b32 v20, v22
    s_cmp_lg_u32 s31, 0
    s_cbranch_scc1 P1_L_NOZ
    s_mov_b32 s52, s20
    s_and_b32 s53, s21, 0xffff
    s_mov_b32 s54, 256
    s_mov_b32 s55, 0x00020000
    v_mov_b32 v24, 0
    s_mov_b32 s98, 0
POLL1:
    buffer_load_dword v25, v24, s[52:55], 0 offen sc1
    s_waitcnt vmcnt(0)
    v_readfirstlane_b32 s57, v25
    s_nop 1
    s_cmp_ge_u32 s57, 32
    s_cbranch_scc1 POLL1_OK
    s_sleep 1
    s_add_u32 s98, s98, 1
    s_cmp_lt_u32 s98, 65536
    s_cbranch_scc1 POLL1
POLL1_OK:
P1_L_NOZ:
    s_barrier
    s_branch P1_STORE
P1_CONS:
    s_lshr_b32 s31, s24, 1
    s_and_b32 s32, s24, 1
    v_and_b32 v3, 15, v2
    v_lshrrev_b32 v4, 4, v2
    v_bfe_u32 v5, v2, 2, 2
    v_and_b32 v6, 3, v2
    v_mov_b32 v244, 151552
    v_mov_b32 v16, 0
    v_mov_b32 v17, 0
    v_mov_b32 v18, 0
    v_mov_b32 v19, 0
    ds_write_b128 v244, v[16:19]
    ds_write_b128 v244, v[16:19] offset:16
    ds_write_b128 v244, v[16:19] offset:32
    v_lshlrev_b32 v246, 4, v2
    s_mul_i32 s40, s2, 52429
    s_lshr_b32 s40, s40, 18
    s_mul_i32 s41, s40, 5
    s_sub_u32 s41, s2, s41
    v_lshrrev_b32 v7, 2, v2
    v_mul_u32_u24 v7, 1280, v7
    v_lshl_add_u32 v247, v6, 4, v7
    s_lshl_b32 s42, s24, 11
    s_add_u32 s42, s42, 143360
    s_waitcnt lgkmcnt(0)
    s_mov_b32 s36, s22
    s_and_b32 s37, s23, 0xffff
    s_mov_b32 s38, 268435456
    s_mov_b32 s39, 0x00020000
    s_cmp_ge_u32 s2, 8
    s_cbranch_scc1 P1_C_NOZ
    s_lshl_b32 s43, s2, 2
    s_add_u32 s43, s43, s24
    s_lshl_b32 s43, s43, 11
    s_add_u32 s43, s43, 17375232
    buffer_store_dwordx4 v[16:19], v246, s[36:39], s43 offen sc1
    buffer_store_dwordx4 v[16:19], v246, s[36:39], s43 offen offset:1024 sc1
P1_C_NOZ:
    s_cmp_ge_u32 s2, 200
    s_cbranch_scc1 P1_C_NOWO
    s_cmp_lt_u32 s40, 20
    s_cselect_b32 s52, s8, s14
    s_cselect_b32 s53, s9, s15
    s_cselect_b32 s57, 0, 20
    s_and_b32 s53, s53, 0xffff
    s_mov_b32 s54, 819200
    s_mov_b32 s55, 0x00020000
    s_sub_u32 s57, s40, s57
    s_mul_i32 s57, s57, 40960
    s_lshl_b32 s56, s41, 8
    s_add_u32 s57, s57, s56
    s_lshl_b32 s56, s24, 6
    s_add_u32 s57, s57, s56
    s_mov_b32 m0, s42
    s_add_u32 s56, s57, 20480
    buffer_load_dwordx4 v247, s[52:55], s57 offen lds
    s_add_u32 m0, s42, 1024
    s_nop 0
    buffer_load_dwordx4 v247, s[52:55], s56 offen lds
P1_C_NOWO:
    s_cmp_lg_u32 s24, 2
    s_cbranch_scc1 P1_C_NOCW
    s_getpc_b64 s[44:45]
P1_C_PC:
    s_lshr_b32 s46, s2, 3
    s_lshl_b32 s46, s46, 7
    v_lshlrev_b32 v7, 12, v2
    v_add_u32 v7, s46, v7
    v_cmp_gt_u32 vcc, (KCODE_END - P1_C_PC - 4), v7
    v_mov_b32 v9, s45
    v_add_co_u32 v8, s[46:47], s44, v7
    s_nop 1
    v_addc_co_u32 v9, s[46:47], 0, v9, s[46:47]
    s_and_saveexec_b64 s[46:47], vcc
    global_load_dword v248, v[8:9], off
    s_mov_b64 exec, s[46:47]
P1_C_NOCW:
    s_barrier
    v_lshrrev_b32 v7, 1, v3
    v_xor_b32 v7, v4, v7
    v_lshlrev_b32 v7, 4, v7
    v_lshl_add_u32 v8, v3, 7, v7
    s_lshl_b32 s33, s31, 13
    v_add_u32 v8, s33, v8
    v_xor_b32 v9, 64, v8
    v_lshrrev_b32 v7, 1, v4
    v_lshlrev_b32 v7, 4, v7
    v_and_b32 v1, 1, v4
    v_lshl_add_u32 v7, v1, 2, v7
    v_add_u32 v7, v7, v5
    v_mul_u32_u24 v7, 480, v7
    v_add_u32 v7, 16384, v7
    v_mul_u32_u24 v1, 40, v6
    v_add_u32 v10, v7, v1
    v_lshl_add_u32 v11, v6, 3, v7
    v_lshlrev_b32 v7, 4, v4
    v_add_u32 v7, 141312, v7
    s_lshl_b32 s33, s3, 7
    v_add_u32 v7, s33, v7
    s_sub_u32 s43, 10, s3
    s_mov_b32 s45, 128
    v_mov_b32 v112, 0
    v_mov_b32 v113, 0
    v_mov_b32 v114, 0
    v_mov_b32 v115, 0
    v_mov_b32 v116, 0
    v_mov_b32 v117, 0
    v_mov_b32 v118, 0
    v_mov_b32 v119, 0
    v_mov_b32 v120, 0
    v_mov_b32 v121, 0
    v_mov_b32 v122, 0
    v_mov_b32 v123, 0
    v_mov_b32 v124, 0
    v_mov_b32 v125, 0
    v_mov_b32 v126, 0
    v_mov_b32 v127, 0
    v_mov_b32 v128, 0
    v_mov_b32 v129, 0
    v_mov_b32 v130, 0
    v_mov_b32 v131, 0
    v_mov_b32 v132, 0
    v_mov_b32 v133, 0
    v_mov_b32 v134, 0
    v_mov_b32 v135, 0
    v_mov_b32 v136, 0
    v_mov_b32 v137, 0
    v_mov_b32 v138, 0
    v_mov_b32 v139, 0
    v_mov_b32 v140, 0
    v_mov_b32 v141, 0
    v_mov_b32 v142, 0
    v_mov_b32 v143, 0
    v_mov_b32 v144, 0
    v_mov_b32 v145, 0
    v_mov_b32 v146, 0
    v_mov_b32 v147, 0
    v_mov_b32 v148, 0
    v_mov_b32 v149, 0
    v_mov_b32 v150, 0
    v_mov_b32 v151, 0
    v_mov_b32 v152, 0
    v_mov_b32 v153, 0
    v_mov_b32 v154, 0
    v_mov_b32 v155, 0
    v_mov_b32 v156, 0
    v_mov_b32 v157, 0
    v_mov_b32 v158, 0
    v_mov_b32 v159, 0
    v_mov_b32 v160, 0
    v_mov_b32 v161, 0
    v_mov_b32 v162, 0
    v_mov_b32 v163, 0
    v_mov_b32 v164, 0
    v_mov_b32 v165, 0
    v_mov_b32 v166, 0
    v_mov_b32 v167, 0
    v_mov_b32 v168, 0
    v_mov_b32 v169, 0
    v_mov_b32 v170, 0
    v_mov_b32 v171, 0
    v_mov_b32 v172, 0
    v_mov_b32 v173, 0
    v_mov_b32 v174, 0
    v_mov_b32 v175, 0
    v_mov_b32 v176, 0
    v_mov_b32 v177, 0
    v_mov_b32 v178, 0
    v_mov_b32 v179, 0
    v_mov_b32 v180, 0
    v_mov_b32 v181, 0
    v_mov_b32 v182, 0
    v_mov_b32 v183, 0
    v_mov_b32 v184, 0
    v_mov_b32 v185, 0
    v_mov_b32 v186, 0
    v_mov_b32 v187, 0
    v_mov_b32 v188, 0
    v_mov_b32 v189, 0
    v_mov_b32 v190, 0
    v_mov_b32 v191, 0
    v_mov_b32 v192, 0
    v_mov_b32 v193, 0
    v_mov_b32 v194, 0
    v_mov_b32 v195, 0
    v_mov_b32 v196, 0
    v_mov_b32 v197, 0
    v_mov_b32 v198, 0
    v_mov_b32 v199, 0
    v_mov_b32 v200, 0
    v_mov_b32 v201, 0
    v_mov_b32 v202, 0
    v_mov_b32 v203, 0
    v_mov_b32 v204, 0
    v_mov_b32 v205, 0
    v_mov_b32 v206, 0
    v_mov_b32 v207, 0
    v_mov_b32 v208, 0
    v_mov_b32 v209, 0
    v_mov_b32 v210, 0
    v_mov_b32 v211, 0
    v_mov_b32 v212, 0
    v_mov_b32 v213, 0
    v_mov_b32 v214, 0
    v_mov_b32 v215, 0
    v_mov_b32 v216, 0
    v_mov_b32 v217, 0
    v_mov_b32 v218, 0
    v_mov_b32 v219, 0
    v_mov_b32 v220, 0
    v_mov_b32 v221, 0
    v_mov_b32 v222, 0
    v_mov_b32 v223, 0
    v_mov_b32 v224, 0
    v_mov_b32 v225, 0
    v_mov_b32 v226, 0
    v_mov_b32 v227, 0
    v_mov_b32 v228, 0
    v_mov_b32 v229, 0
    v_mov_b32 v230, 0
    v_mov_b32 v231, 0
    v_mov_b32 v232, 0
    v_mov_b32 v233, 0
    v_mov_b32 v234, 0
    v_mov_b32 v235, 0
    v_mov_b32 v236, 0
    v_mov_b32 v237, 0
    v_mov_b32 v238, 0
    v_mov_b32 v239, 0
    v_mov_b32 v12, v8
    v_mov_b32 v13, v9
    v_mov_b32 v14, v10
    v_mov_b32 v15, v11
    s_lshl_b32 s33, s24, 2
    s_add_u32 s33, s33, 151568
    v_mov_b32 v245, s33
    s_mov_b32 s34, 0
    s_mov_b32 s35, 1
    v_lshlrev_b32 v1, 9, v4
    v_lshl_add_u32 v1, v5, 6, v1
    v_lshl_add_u32 v1, v6, 3, v1
    v_add_u32 v1, s42, v1
    s_waitcnt vmcnt(0)
    s_cmp_ge_u32 s2, 8
    s_cbranch_scc1 P1_C_NOZ2
    s_mov_b32 s52, s20
    s_and_b32 s53, s21, 0xffff
    s_mov_b32 s54, 256
    s_mov_b32 s55, 0x00020000
    v_mov_b32 v16, 1
    v_mov_b32 v17, 0
    s_mov_b64 exec, 1
    buffer_atomic_add v16, v17, s[52:55], 0 offen sc1
    s_mov_b64 exec, -1
P1_C_NOZ2:
    s_cmp_ge_u32 s2, 200
    s_cbranch_scc1 P1_C_NOWO2
    ds_read_b64_tr_b16 v[64:65], v1 offset:0
    ds_read_b64_tr_b16 v[66:67], v1 offset:256
    ds_read_b64_tr_b16 v[68:69], v1 offset:32
    ds_read_b64_tr_b16 v[70:71], v1 offset:288
    s_lshl_b32 s57, s41, 3
    s_lshl_b32 s58, s24, 1
    s_add_u32 s57, s57, s58
    s_mul_i32 s57, s57, 40
    s_add_u32 s57, s57, s40
    s_lshl_b32 s57, s57, 10
    s_add_u32 s57, s57, 15736832
    s_add_u32 s58, s57, 40960
    s_waitcnt lgkmcnt(0)
    buffer_store_dwordx4 v[64:67], v246, s[36:39], s57 offen sc1
    buffer_store_dwordx4 v[68:71], v246, s[36:39], s58 offen sc1
P1_C_NOWO2:
P1_C_W0:
    ds_read_b128 v[240:243], v244
    s_waitcnt lgkmcnt(0)
    v_min3_u32 v1, v240, v241, v242
    v_min_u32 v1, v1, v243
    s_nop 0
    v_readfirstlane_b32 s40, v1
    s_add_u32 s98, s98, 1
    s_cmp_gt_u32 s98, 524288
    s_cbranch_scc1 P1_C_W0X
    s_cmp_lt_u32 s40, 2
    s_cbranch_scc1 P1_C_W0
P1_C_W0X:
    s_setprio 2
    s_lshl_b32 s40, s29, 1
    s_add_u32 s40, s40, s32
    s_cmp_eq_u32 s40, 1
    s_cbranch_scc1 P1_V1
    s_cmp_eq_u32 s40, 2
    s_cbranch_scc1 P1_V2
    s_cmp_eq_u32 s40, 3
    s_cbranch_scc1 P1_V3
P1_V0:
    ds_read_b128 v[16:19], v12 offset:0
    ds_read_b128 v[20:23], v12 offset:2048
    ds_read_b128 v[24:27], v12 offset:4096
    ds_read_b128 v[28:31], v12 offset:6144
    ds_read_b64_tr_b16 v[32:33], v14 offset:0
    ds_read_b64_tr_b16 v[34:35], v14 offset:3840
    ds_read_b64_tr_b16 v[36:37], v14 offset:8
    ds_read_b64_tr_b16 v[38:39], v14 offset:3848
    ds_read_b64_tr_b16 v[40:41], v14 offset:16
    ds_read_b64_tr_b16 v[42:43], v14 offset:3856
    ds_read_b64_tr_b16 v[44:45], v14 offset:24
    ds_read_b64_tr_b16 v[46:47], v14 offset:3864
    ds_read_b64_tr_b16 v[48:49], v14 offset:32
    ds_read_b64_tr_b16 v[50:51], v14 offset:3872
    ds_read_b64_tr_b16 v[52:53], v14 offset:160
    ds_read_b64_tr_b16 v[54:55], v14 offset:4000
    ds_read_b64_tr_b16 v[56:57], v14 offset:168
    ds_read_b64_tr_b16 v[58:59], v14 offset:4008
    ds_read_b64_tr_b16 v[60:61], v14 offset:176
    ds_read_b64_tr_b16 v[62:63], v14 offset:4016
    ds_read_b128 v[240:243], v244
    s_mov_b32 s35, 3
    s_mov_b32 s41, 2
    v_mov_b32 v1, 1
    s_mov_b32 s33, 0
    s_waitcnt lgkmcnt(0)
    ds_write_b32 v245, v1
P1_V0_LOOP:
    v_mfma_f32_16x16x32_bf16 v[112:115], v[32:35], v[16:19], v[112:115]
    v_min3_u32 v1, v240, v241, v242
    v_min_u32 v1, v1, v243
    v_mfma_f32_16x16x32_bf16 v[116:119], v[32:35], v[20:23], v[116:119]
    v_readfirstlane_b32 s40, v1
    v_mfma_f32_16x16x32_bf16 v[120:123], v[32:35], v[24:27], v[120:123]
    s_nop 0
    s_cmp_lt_u32 s40, s35
    s_cbranch_scc1 P1_V0_A_SPIN
P1_V0_A_GO:
    ds_read_b128 v[64:67], v13 offset:0
    v_mfma_f32_16x16x32_bf16 v[124:127], v[32:35], v[28:31], v[124:127]
    ds_read_b64_tr_b16 v[80:81], v14 offset:15360
    v_mfma_f32_16x16x32_bf16 v[128:131], v[36:39], v[16:19], v[128:131]
    ds_read_b128 v[68:71], v13 offset:2048
    v_mfma_f32_16x16x32_bf16 v[132:135], v[36:39], v[20:23], v[132:135]
    ds_read_b64_tr_b16 v[82:83], v14 offset:19200
    v_mfma_f32_16x16x32_bf16 v[136:139], v[36:39], v[24:27], v[136:139]
    ds_read_b128 v[72:75], v13 offset:4096
    v_mfma_f32_16x16x32_bf16 v[140:143], v[36:39], v[28:31], v[140:143]
    ds_read_b64_tr_b16 v[84:85], v14 offset:15368
    v_mfma_f32_16x16x32_bf16 v[144:147], v[40:43], v[16:19], v[144:147]
    ds_read_b128 v[76:79], v13 offset:6144
    v_mfma_f32_16x16x32_bf16 v[148:151], v[40:43], v[20:23], v[148:151]
    ds_read_b64_tr_b16 v[86:87], v14 offset:19208
    v_mfma_f32_16x16x32_bf16 v[152:155], v[40:43], v[24:27], v[152:155]
    ds_read_b64_tr_b16 v[88:89], v14 offset:15376
    v_mfma_f32_16x16x32_bf16 v[156:159], v[40:43], v[28:31], v[156:159]
    ds_read_b64_tr_b16 v[90:91], v14 offset:19216
    v_mfma_f32_16x16x32_bf16 v[160:163], v[44:47], v[16:19], v[160:163]
    ds_read_b64_tr_b16 v[92:93], v14 offset:15384
    v_mfma_f32_16x16x32_bf16 v[164:167], v[44:47], v[20:23], v[164:167]
    ds_read_b64_tr_b16 v[94:95], v14 offset:19224
    v_mfma_f32_16x16x32_bf16 v[168:171], v[44:47], v[24:27], v[168:171]
    ds_read_b64_tr_b16 v[96:97], v14 offset:15392
    v_mfma_f32_16x16x32_bf16 v[172:175], v[44:47], v[28:31], v[172:175]
    ds_read_b64_tr_b16 v[98:99], v14 offset:19232
    v_mfma_f32_16x16x32_bf16 v[176:179], v[48:51], v[16:19], v[176:179]
    ds_read_b64_tr_b16 v[100:101], v14 offset:15520
    v_mfma_f32_16x16x32_bf16 v[180:183], v[48:51], v[20:23], v[180:183]
    ds_read_b64_tr_b16 v[102:103], v14 offset:19360
    v_mfma_f32_16x16x32_bf16 v[184:187], v[48:51], v[24:27], v[184:187]
    ds_read_b64_tr_b16 v[104:105], v14 offset:15528
    v_mfma_f32_16x16x32_bf16 v[188:191], v[48:51], v[28:31], v[188:191]
    ds_read_b64_tr_b16 v[106:107], v14 offset:19368
    v_mfma_f32_16x16x32_bf16 v[192:195], v[52:55], v[16:19], v[192:195]
    ds_read_b64_tr_b16 v[108:109], v14 offset:15536
    v_mfma_f32_16x16x32_bf16 v[196:199], v[52:55], v[20:23], v[196:199]
    ds_read_b64_tr_b16 v[110:111], v14 offset:19376
    v_mfma_f32_16x16x32_bf16 v[200:203], v[52:55], v[24:27], v[200:203]
    ds_read_b128 v[240:243], v244
    v_mfma_f32_16x16x32_bf16 v[204:207], v[52:55], v[28:31], v[204:207]
    v_mfma_f32_16x16x32_bf16 v[208:211], v[56:59], v[16:19], v[208:211]
    v_mfma_f32_16x16x32_bf16 v[212:215], v[56:59], v[20:23], v[212:215]
    v_mfma_f32_16x16x32_bf16 v[216:219], v[56:59], v[24:27], v[216:219]
    v_mfma_f32_16x16x32_bf16 v[220:223], v[56:59], v[28:31], v[220:223]
    v_mfma_f32_16x16x32_bf16 v[224:227], v[60:63], v[16:19], v[224:227]
    v_mfma_f32_16x16x32_bf16 v[228:231], v[60:63], v[20:23], v[228:231]
    v_mfma_f32_16x16x32_bf16 v[232:235], v[60:63], v[24:27], v[232:235]
    v_mfma_f32_16x16x32_bf16 v[236:239], v[60:63], v[28:31], v[236:239]
    v_mov_b32 v1, s41
    s_add_u32 s41, s41, 1
    s_add_u32 s35, s35, 2
    s_min_u32 s35, s35, 30
    s_waitcnt lgkmcnt(0)
    ds_write_b32 v245, v1
    v_mfma_f32_16x16x32_bf16 v[112:115], v[80:83], v[64:67], v[112:115]
    v_min3_u32 v1, v240, v241, v242
    v_min_u32 v1, v1, v243
    v_mfma_f32_16x16x32_bf16 v[116:119], v[80:83], v[68:71], v[116:119]
    v_readfirstlane_b32 s40, v1
    s_add_u32 s34, s34, 47104
    s_cmp_eq_u32 s34, 141312
    s_cselect_b32 s34, 0, s34
    v_add_u32 v12, s34, v8
    v_add_u32 v13, s34, v9
    v_add_u32 v14, s34, v10
    v_add_u32 v15, s34, v11
    v_mfma_f32_16x16x32_bf16 v[120:123], v[80:83], v[72:75], v[120:123]
    s_cmp_lt_u32 s40, s35
    s_cbranch_scc1 P1_V0_B_SPIN
P1_V0_B_GO:
    ds_read_b128 v[16:19], v12 offset:0
    v_mfma_f32_16x16x32_bf16 v[124:127], v[80:83], v[76:79], v[124:127]
    ds_read_b64_tr_b16 v[32:33], v14 offset:0
    v_mfma_f32_16x16x32_bf16 v[128:131], v[84:87], v[64:67], v[128:131]
    ds_read_b128 v[20:23], v12 offset:2048
    v_mfma_f32_16x16x32_bf16 v[132:135], v[84:87], v[68:71], v[132:135]
    ds_read_b64_tr_b16 v[34:35], v14 offset:3840
    v_mfma_f32_16x16x32_bf16 v[136:139], v[84:87], v[72:75], v[136:139]
    ds_read_b128 v[24:27], v12 offset:4096
    v_mfma_f32_16x16x32_bf16 v[140:143], v[84:87], v[76:79], v[140:143]
    ds_read_b64_tr_b16 v[36:37], v14 offset:8
    v_mfma_f32_16x16x32_bf16 v[144:147], v[88:91], v[64:67], v[144:147]
    ds_read_b128 v[28:31], v12 offset:6144
    v_mfma_f32_16x16x32_bf16 v[148:151], v[88:91], v[68:71], v[148:151]
    ds_read_b64_tr_b16 v[38:39], v14 offset:3848
    v_mfma_f32_16x16x32_bf16 v[152:155], v[88:91], v[72:75], v[152:155]
    ds_read_b64_tr_b16 v[40:41], v14 offset:16
    v_mfma_f32_16x16x32_bf16 v[156:159], v[88:91], v[76:79], v[156:159]
    ds_read_b64_tr_b16 v[42:43], v14 offset:3856
    v_mfma_f32_16x16x32_bf16 v[160:163], v[92:95], v[64:67], v[160:163]
    ds_read_b64_tr_b16 v[44:45], v14 offset:24
    v_mfma_f32_16x16x32_bf16 v[164:167], v[92:95], v[68:71], v[164:167]
    ds_read_b64_tr_b16 v[46:47], v14 offset:3864
    v_mfma_f32_16x16x32_bf16 v[168:171], v[92:95], v[72:75], v[168:171]
    ds_read_b64_tr_b16 v[48:49], v14 offset:32
    v_mfma_f32_16x16x32_bf16 v[172:175], v[92:95], v[76:79], v[172:175]
    ds_read_b64_tr_b16 v[50:51], v14 offset:3872
    v_mfma_f32_16x16x32_bf16 v[176:179], v[96:99], v[64:67], v[176:179]
    ds_read_b64_tr_b16 v[52:53], v14 offset:160
    v_mfma_f32_16x16x32_bf16 v[180:183], v[96:99], v[68:71], v[180:183]
    ds_read_b64_tr_b16 v[54:55], v14 offset:4000
    v_mfma_f32_16x16x32_bf16 v[184:187], v[96:99], v[72:75], v[184:187]
    ds_read_b64_tr_b16 v[56:57], v14 offset:168
    v_mfma_f32_16x16x32_bf16 v[188:191], v[96:99], v[76:79], v[188:191]
    ds_read_b64_tr_b16 v[58:59], v14 offset:4008
    v_mfma_f32_16x16x32_bf16 v[192:195], v[100:103], v[64:67], v[192:195]
    ds_read_b64_tr_b16 v[60:61], v14 offset:176
    v_mfma_f32_16x16x32_bf16 v[196:199], v[100:103], v[68:71], v[196:199]
    ds_read_b64_tr_b16 v[62:63], v14 offset:4016
    v_mfma_f32_16x16x32_bf16 v[200:203], v[100:103], v[72:75], v[200:203]
    ds_read_b128 v[240:243], v244
    v_mfma_f32_16x16x32_bf16 v[204:207], v[100:103], v[76:79], v[204:207]
    v_mfma_f32_16x16x32_bf16 v[208:211], v[104:107], v[64:67], v[208:211]
    v_mfma_f32_16x16x32_bf16 v[212:215], v[104:107], v[68:71], v[212:215]
    v_mfma_f32_16x16x32_bf16 v[216:219], v[104:107], v[72:75], v[216:219]
    v_mfma_f32_16x16x32_bf16 v[220:223], v[104:107], v[76:79], v[220:223]
    v_mfma_f32_16x16x32_bf16 v[224:227], v[108:111], v[64:67], v[224:227]
    v_mfma_f32_16x16x32_bf16 v[228:231], v[108:111], v[68:71], v[228:231]
    v_mfma_f32_16x16x32_bf16 v[232:235], v[108:111], v[72:75], v[232:235]
    v_mfma_f32_16x16x32_bf16 v[236:239], v[108:111], v[76:79], v[236:239]
    v_mov_b32 v1, s41
    s_add_u32 s41, s41, 1
    s_add_u32 s35, s35, 1
    s_min_u32 s35, s35, 30
    s_waitcnt lgkmcnt(0)
    ds_write_b32 v245, v1
    s_add_u32 s33, s33, 1
    s_cmp_lt_u32 s33, 10
    s_cbranch_scc1 P1_V0_LOOP
    s_setprio 0
    s_lshl_b32 s40, s31, 6
    v_lshl_add_u32 v1, v4, 7, v3
    v_add_u32 v1, s40, v1
    v_mul_u32_u24 v1, 40, v1
    s_waitcnt lgkmcnt(0)
    s_barrier
    v_cvt_pk_bf16_f32 v16, v192, v193
    v_cvt_pk_bf16_f32 v17, v194, v195
    ds_write_b64 v1, v[16:17] offset:20480
    v_cvt_pk_bf16_f32 v18, v208, v209
    v_cvt_pk_bf16_f32 v19, v210, v211
    ds_write_b64 v1, v[18:19] offset:20488
    v_cvt_pk_bf16_f32 v20, v224, v225
    v_cvt_pk_bf16_f32 v21, v226, v227
    ds_write_b64 v1, v[20:21] offset:20496
    v_cvt_pk_bf16_f32 v22, v196, v197
    v_cvt_pk_bf16_f32 v23, v198, v199
    ds_write_b64 v1, v[22:23] offset:21120
    v_cvt_pk_bf16_f32 v24, v212, v213
    v_cvt_pk_bf16_f32 v25, v214, v215
    ds_write_b64 v1, v[24:25] offset:21128
    v_cvt_pk_bf16_f32 v26, v228, v229
    v_cvt_pk_bf16_f32 v27, v230, v231
    ds_write_b64 v1, v[26:27] offset:21136
    v_cvt_pk_bf16_f32 v28, v200, v201
    v_cvt_pk_bf16_f32 v29, v202, v203
    ds_write_b64 v1, v[28:29] offset:21760
    v_cvt_pk_bf16_f32 v30, v216, v217
    v_cvt_pk_bf16_f32 v31, v218, v219
    ds_write_b64 v1, v[30:31] offset:21768
    v_cvt_pk_bf16_f32 v16, v232, v233
    v_cvt_pk_bf16_f32 v17, v234, v235
    ds_write_b64 v1, v[16:17] offset:21776
    v_cvt_pk_bf16_f32 v18, v204, v205
    v_cvt_pk_bf16_f32 v19, v206, v207
    ds_write_b64 v1, v[18:19] offset:22400
    v_cvt_pk_bf16_f32 v20, v220, v221
    v_cvt_pk_bf16_f32 v21, v222, v223
    ds_write_b64 v1, v[20:21] offset:22408
    v_cvt_pk_bf16_f32 v22, v236, v237
    v_cvt_pk_bf16_f32 v23, v238, v239
    ds_write_b64 v1, v[22:23] offset:22416
    v_cvt_pk_bf16_f32 v16, v112, v113
    v_cvt_pk_bf16_f32 v17, v114, v115
    ds_write_b64 v1, v[16:17] offset:0
    v_cvt_pk_bf16_f32 v18, v128, v129
    v_cvt_pk_bf16_f32 v19, v130, v131
    ds_write_b64 v1, v[18:19] offset:8
    v_cvt_pk_bf16_f32 v20, v144, v145
    v_cvt_pk_bf16_f32 v21, v146, v147
    ds_write_b64 v1, v[20:21] offset:16
    v_cvt_pk_bf16_f32 v22, v160, v161
    v_cvt_pk_bf16_f32 v23, v162, v163
    ds_write_b64 v1, v[22:23] offset:24
    v_cvt_pk_bf16_f32 v24, v176, v177
    v_cvt_pk_bf16_f32 v25, v178, v179
    ds_write_b64 v1, v[24:25] offset:32
    v_cvt_pk_bf16_f32 v26, v116, v117
    v_cvt_pk_bf16_f32 v27, v118, v119
    ds_write_b64 v1, v[26:27] offset:640
    v_cvt_pk_bf16_f32 v28, v132, v133
    v_cvt_pk_bf16_f32 v29, v134, v135
    ds_write_b64 v1, v[28:29] offset:648
    v_cvt_pk_bf16_f32 v30, v148, v149
    v_cvt_pk_bf16_f32 v31, v150, v151
    ds_write_b64 v1, v[30:31] offset:656
    v_cvt_pk_bf16_f32 v16, v164, v165
    v_cvt_pk_bf16_f32 v17, v166, v167
    ds_write_b64 v1, v[16:17] offset:664
    v_cvt_pk_bf16_f32 v18, v180, v181
    v_cvt_pk_bf16_f32 v19, v182, v183
    ds_write_b64 v1, v[18:19] offset:672
    v_cvt_pk_bf16_f32 v20, v120, v121
    v_cvt_pk_bf16_f32 v21, v122, v123
    ds_write_b64 v1, v[20:21] offset:1280
    v_cvt_pk_bf16_f32 v22, v136, v137
    v_cvt_pk_bf16_f32 v23, v138, v139
    ds_write_b64 v1, v[22:23] offset:1288
    v_cvt_pk_bf16_f32 v24, v152, v153
    v_cvt_pk_bf16_f32 v25, v154, v155
    ds_write_b64 v1, v[24:25] offset:1296
    v_cvt_pk_bf16_f32 v26, v168, v169
    v_cvt_pk_bf16_f32 v27, v170, v171
    ds_write_b64 v1, v[26:27] offset:1304
    v_cvt_pk_bf16_f32 v28, v184, v185
    v_cvt_pk_bf16_f32 v29, v186, v187
    ds_write_b64 v1, v[28:29] offset:1312
    v_cvt_pk_bf16_f32 v30, v124, v125
    v_cvt_pk_bf16_f32 v31, v126, v127
    ds_write_b64 v1, v[30:31] offset:1920
    v_cvt_pk_bf16_f32 v16, v140, v141
    v_cvt_pk_bf16_f32 v17, v142, v143
    ds_write_b64 v1, v[16:17] offset:1928
    v_cvt_pk_bf16_f32 v18, v156, v157
    v_cvt_pk_bf16_f32 v19, v158, v159
    ds_write_b64 v1, v[18:19] offset:1936
    v_cvt_pk_bf16_f32 v20, v172, v173
    v_cvt_pk_bf16_f32 v21, v174, v175
    ds_write_b64 v1, v[20:21] offset:1944
    v_cvt_pk_bf16_f32 v22, v188, v189
    v_cvt_pk_bf16_f32 v23, v190, v191
    ds_write_b64 v1, v[22:23] offset:1952
    s_branch P1_STORE
P1_V1:
    ds_read_b128 v[16:19], v12 offset:0
    ds_read_b128 v[20:23], v12 offset:2048
    ds_read_b128 v[24:27], v12 offset:4096
    ds_read_b128 v[28:31], v12 offset:6144
    ds_read_b64_tr_b16 v[32:33], v14 offset:184
    ds_read_b64_tr_b16 v[34:35], v14 offset:4024
    ds_read_b64_tr_b16 v[36:37], v14 offset:192
    ds_read_b64_tr_b16 v[38:39], v14 offset:4032
    ds_read_b64_tr_b16 v[40:41], v15 offset:320
    ds_read_b64_tr_b16 v[42:43], v15 offset:4160
    ds_read_b64_tr_b16 v[44:45], v15 offset:352
    ds_read_b64_tr_b16 v[46:47], v15 offset:4192
    ds_read_b64_tr_b16 v[48:49], v15 offset:384
    ds_read_b64_tr_b16 v[50:51], v15 offset:4224
    ds_read_b64_tr_b16 v[52:53], v15 offset:416
    ds_read_b64_tr_b16 v[54:55], v15 offset:4256
    ds_read_b64_tr_b16 v[56:57], v15 offset:448
    ds_read_b64_tr_b16 v[58:59], v15 offset:4288
    ds_read_b128 v[60:63], v7 offset:0
    ds_read_b128 v[240:243], v244
    s_mov_b32 s35, 3
    s_mov_b32 s41, 2
    v_mov_b32 v1, 1
    s_mov_b32 s33, 0
    s_waitcnt lgkmcnt(0)
    ds_write_b32 v245, v1
P1_V1_LOOP:
    v_mfma_f32_16x16x32_bf16 v[112:115], v[32:35], v[16:19], v[112:115]
    v_min3_u32 v1, v240, v241, v242
    v_min_u32 v1, v1, v243
    v_mfma_f32_16x16x32_bf16 v[116:119], v[32:35], v[20:23], v[116:119]
    v_readfirstlane_b32 s40, v1
    v_mfma_f32_16x16x32_bf16 v[120:123], v[32:35], v[24:27], v[120:123]
    s_nop 0
    s_cmp_lt_u32 s40, s35
    s_cbranch_scc1 P1_V1_A_SPIN
P1_V1_A_GO:
    ds_read_b128 v[64:67], v13 offset:0
    v_mfma_f32_16x16x32_bf16 v[124:127], v[32:35], v[28:31], v[124:127]
    ds_read_b64_tr_b16 v[80:81], v14 offset:15544
    v_mfma_f32_16x16x32_bf16 v[128:131], v[36:39], v[16:19], v[128:131]
    ds_read_b128 v[68:71], v13 offset:2048
    v_mfma_f32_16x16x32_bf16 v[132:135], v[36:39], v[20:23], v[132:135]
    ds_read_b64_tr_b16 v[82:83], v14 offset:19384
    v_mfma_f32_16x16x32_bf16 v[136:139], v[36:39], v[24:27], v[136:139]
    ds_read_b128 v[72:75], v13 offset:4096
    v_mfma_f32_16x16x32_bf16 v[140:143], v[36:39], v[28:31], v[140:143]
    ds_read_b64_tr_b16 v[84:85], v14 offset:15552
    v_mfma_f32_16x16x32_bf16 v[144:147], v[16:19], v[40:43], v[144:147]
    ds_read_b128 v[76:79], v13 offset:6144
    v_mfma_f32_16x16x32_bf16 v[148:151], v[20:23], v[40:43], v[148:151]
    ds_read_b64_tr_b16 v[86:87], v14 offset:19392
    v_mfma_f32_16x16x32_bf16 v[152:155], v[24:27], v[40:43], v[152:155]
    ds_read_b64_tr_b16 v[88:89], v15 offset:15680
    v_mfma_f32_16x16x32_bf16 v[156:159], v[28:31], v[40:43], v[156:159]
    ds_read_b64_tr_b16 v[90:91], v15 offset:19520
    v_mfma_f32_16x16x32_bf16 v[160:163], v[16:19], v[44:47], v[160:163]
    ds_read_b64_tr_b16 v[92:93], v15 offset:15712
    v_mfma_f32_16x16x32_bf16 v[164:167], v[20:23], v[44:47], v[164:167]
    ds_read_b64_tr_b16 v[94:95], v15 offset:19552
    v_mfma_f32_16x16x32_bf16 v[168:171], v[24:27], v[44:47], v[168:171]
    ds_read_b64_tr_b16 v[96:97], v15 offset:15744
    v_mfma_f32_16x16x32_bf16 v[172:175], v[28:31], v[44:47], v[172:175]
    ds_read_b64_tr_b16 v[98:99], v15 offset:19584
    v_mfma_f32_16x16x32_bf16 v[176:179], v[16:19], v[48:51], v[176:179]
    ds_read_b64_tr_b16 v[100:101], v15 offset:15776
    v_mfma_f32_16x16x32_bf16 v[180:183], v[20:23], v[48:51], v[180:183]
    ds_read_b64_tr_b16 v[102:103], v15 offset:19616
    v_mfma_f32_16x16x32_bf16 v[184:187], v[24:27], v[48:51], v[184:187]
    ds_read_b64_tr_b16 v[104:105], v15 offset:15808
    v_mfma_f32_16x16x32_bf16 v[188:191], v[28:31], v[48:51], v[188:191]
    ds_read_b64_tr_b16 v[106:107], v15 offset:19648
    v_mfma_f32_16x16x32_bf16 v[192:195], v[16:19], v[52:55], v[192:195]
    ds_read_b128 v[108:111], v7 offset:64
    v_mfma_f32_16x16x32_bf16 v[196:199], v[20:23], v[52:55], v[196:199]
    ds_read_b128 v[240:243], v244
    v_mfma_f32_16x16x32_bf16 v[200:203], v[24:27], v[52:55], v[200:203]
    v_mfma_f32_16x16x32_bf16 v[204:207], v[28:31], v[52:55], v[204:207]
    v_mfma_f32_16x16x32_bf16 v[208:211], v[16:19], v[56:59], v[208:211]
    v_mfma_f32_16x16x32_bf16 v[212:215], v[20:23], v[56:59], v[212:215]
    v_mfma_f32_16x16x32_bf16 v[216:219], v[24:27], v[56:59], v[216:219]
    v_mfma_f32_16x16x32_bf16 v[220:223], v[28:31], v[56:59], v[220:223]
    v_mfma_f32_16x16x32_bf16 v[224:227], v[60:63], v[16:19], v[224:227]
    v_mfma_f32_16x16x32_bf16 v[228:231], v[60:63], v[20:23], v[228:231]
    v_mfma_f32_16x16x32_bf16 v[232:235], v[60:63], v[24:27], v[232:235]
    v_mfma_f32_16x16x32_bf16 v[236:239], v[60:63], v[28:31], v[236:239]
    v_mov_b32 v1, s41
    s_add_u32 s41, s41, 1
    s_add_u32 s35, s35, 2
    s_min_u32 s35, s35, 30
    s_waitcnt lgkmcnt(0)
    ds_write_b32 v245, v1
    v_mfma_f32_16x16x32_bf16 v[112:115], v[80:83], v[64:67], v[112:115]
    v_min3_u32 v1, v240, v241, v242
    v_min_u32 v1, v1, v243
    v_mfma_f32_16x16x32_bf16 v[116:119], v[80:83], v[68:71], v[116:119]
    v_readfirstlane_b32 s40, v1
    s_add_u32 s34, s34, 47104
    s_cmp_eq_u32 s34, 141312
    s_cselect_b32 s34, 0, s34
    v_add_u32 v12, s34, v8
    v_add_u32 v13, s34, v9
    v_add_u32 v14, s34, v10
    v_add_u32 v15, s34, v11
    s_sub_u32 s43, s43, 1
    s_cmp_eq_u32 s43, 0
    s_cselect_b32 s44, -1152, s45
    v_add_u32 v7, s44, v7
    v_mfma_f32_16x16x32_bf16 v[120:123], v[80:83], v[72:75], v[120:123]
    s_cmp_lt_u32 s40, s35
    s_cbranch_scc1 P1_V1_B_SPIN
P1_V1_B_GO:
    ds_read_b128 v[16:19], v12 offset:0
    v_mfma_f32_16x16x32_bf16 v[124:127], v[80:83], v[76:79], v[124:127]
    ds_read_b64_tr_b16 v[32:33], v14 offset:184
    v_mfma_f32_16x16x32_bf16 v[128:131], v[84:87], v[64:67], v[128:131]
    ds_read_b128 v[20:23], v12 offset:2048
    v_mfma_f32_16x16x32_bf16 v[132:135], v[84:87], v[68:71], v[132:135]
    ds_read_b64_tr_b16 v[34:35], v14 offset:4024
    v_mfma_f32_16x16x32_bf16 v[136:139], v[84:87], v[72:75], v[136:139]
    ds_read_b128 v[24:27], v12 offset:4096
    v_mfma_f32_16x16x32_bf16 v[140:143], v[84:87], v[76:79], v[140:143]
    ds_read_b64_tr_b16 v[36:37], v14 offset:192
    v_mfma_f32_16x16x32_bf16 v[144:147], v[64:67], v[88:91], v[144:147]
    ds_read_b128 v[28:31], v12 offset:6144
    v_mfma_f32_16x16x32_bf16 v[148:151], v[68:71], v[88:91], v[148:151]
    ds_read_b64_tr_b16 v[38:39], v14 offset:4032
    v_mfma_f32_16x16x32_bf16 v[152:155], v[72:75], v[88:91], v[152:155]
    ds_read_b64_tr_b16 v[40:41], v15 offset:320
    v_mfma_f32_16x16x32_bf16 v[156:159], v[76:79], v[88:91], v[156:159]
    ds_read_b64_tr_b16 v[42:43], v15 offset:4160
    v_mfma_f32_16x16x32_bf16 v[160:163], v[64:67], v[92:95], v[160:163]
    ds_read_b64_tr_b16 v[44:45], v15 offset:352
    v_mfma_f32_16x16x32_bf16 v[164:167], v[68:71], v[92:95], v[164:167]
    ds_read_b64_tr_b16 v[46:47], v15 offset:4192
    v_mfma_f32_16x16x32_bf16 v[168:171], v[72:75], v[92:95], v[168:171]
    ds_read_b64_tr_b16 v[48:49], v15 offset:384
    v_mfma_f32_16x16x32_bf16 v[172:175], v[76:79], v[92:95], v[172:175]
    ds_read_b64_tr_b16 v[50:51], v15 offset:4224
    v_mfma_f32_16x16x32_bf16 v[176:179], v[64:67], v[96:99], v[176:179]
    ds_read_b64_tr_b16 v[52:53], v15 offset:416
    v_mfma_f32_16x16x32_bf16 v[180:183], v[68:71], v[96:99], v[180:183]
    ds_read_b64_tr_b16 v[54:55], v15 offset:4256
    v_mfma_f32_16x16x32_bf16 v[184:187], v[72:75], v[96:99], v[184:187]
    ds_read_b64_tr_b16 v[56:57], v15 offset:448
    v_mfma_f32_16x16x32_bf16 v[188:191], v[76:79], v[96:99], v[188:191]
    ds_read_b64_tr_b16 v[58:59], v15 offset:4288
    v_mfma_f32_16x16x32_bf16 v[192:195], v[64:67], v[100:103], v[192:195]
    ds_read_b128 v[60:63], v7 offset:0
    v_mfma_f32_16x16x32_bf16 v[196:199], v[68:71], v[100:103], v[196:199]
    ds_read_b128 v[240:243], v244
    v_mfma_f32_16x16x32_bf16 v[200:203], v[72:75], v[100:103], v[200:203]
    v_mfma_f32_16x16x32_bf16 v[204:207], v[76:79], v[100:103], v[204:207]
    v_mfma_f32_16x16x32_bf16 v[208:211], v[64:67], v[104:107], v[208:211]
    v_mfma_f32_16x16x32_bf16 v[212:215], v[68:71], v[104:107], v[212:215]
    v_mfma_f32_16x16x32_bf16 v[216:219], v[72:75], v[104:107], v[216:219]
    v_mfma_f32_16x16x32_bf16 v[220:223], v[76:79], v[104:107], v[220:223]
    v_mfma_f32_16x16x32_bf16 v[224:227], v[108:111], v[64:67], v[224:227]
    v_mfma_f32_16x16x32_bf16 v[228:231], v[108:111], v[68:71], v[228:231]
    v_mfma_f32_16x16x32_bf16 v[232:235], v[108:111], v[72:75], v[232:235]
    v_mfma_f32_16x16x32_bf16 v[236:239], v[108:111], v[76:79], v[236:239]
    v_mov_b32 v1, s41
    s_add_u32 s41, s41, 1
    s_add_u32 s35, s35, 1
    s_min_u32 s35, s35, 30
    s_waitcnt lgkmcnt(0)
    ds_write_b32 v245, v1
    s_add_u32 s33, s33, 1
    s_cmp_lt_u32 s33, 10
    s_cbranch_scc1 P1_V1_LOOP
    s_setprio 0
    s_lshl_b32 s40, s31, 6
    v_lshl_add_u32 v1, v4, 7, v3
    v_add_u32 v1, s40, v1
    v_mul_u32_u24 v1, 40, v1
    s_waitcnt lgkmcnt(0)
    s_barrier
    v_cvt_pk_bf16_f32 v16, v112, v113
    v_cvt_pk_bf16_f32 v17, v114, v115
    ds_write_b64 v1, v[16:17] offset:20504
    v_cvt_pk_bf16_f32 v18, v128, v129
    v_cvt_pk_bf16_f32 v19, v130, v131
    ds_write_b64 v1, v[18:19] offset:20512
    v_cvt_pk_bf16_f32 v20, v116, v117
    v_cvt_pk_bf16_f32 v21, v118, v119
    ds_write_b64 v1, v[20:21] offset:21144
    v_cvt_pk_bf16_f32 v22, v132, v133
    v_cvt_pk_bf16_f32 v23, v134, v135
    ds_write_b64 v1, v[22:23] offset:21152
    v_cvt_pk_bf16_f32 v24, v120, v121
    v_cvt_pk_bf16_f32 v25, v122, v123
    ds_write_b64 v1, v[24:25] offset:21784
    v_cvt_pk_bf16_f32 v26, v136, v137
    v_cvt_pk_bf16_f32 v27, v138, v139
    ds_write_b64 v1, v[26:27] offset:21792
    v_cvt_pk_bf16_f32 v28, v124, v125
    v_cvt_pk_bf16_f32 v29, v126, v127
    ds_write_b64 v1, v[28:29] offset:22424
    v_cvt_pk_bf16_f32 v30, v140, v141
    v_cvt_pk_bf16_f32 v31, v142, v143
    ds_write_b64 v1, v[30:31] offset:22432
    v_mul_u32_u24 v1, 272, v3
    v_lshl_add_u32 v1, v4, 4, v1
    s_lshl_b32 s40, s31, 7
    v_add_u32 v1, s40, v1
    v_cvt_pk_bf16_f32 v32, v144, v145
    v_cvt_pk_bf16_f32 v33, v146, v147
    v_cvt_pk_bf16_f32 v34, v148, v149
    v_cvt_pk_bf16_f32 v35, v150, v151
    ds_write_b128 v1, v[32:35] offset:40960
    v_cvt_pk_bf16_f32 v36, v152, v153
    v_cvt_pk_bf16_f32 v37, v154, v155
    v_cvt_pk_bf16_f32 v38, v156, v157
    v_cvt_pk_bf16_f32 v39, v158, v159
    ds_write_b128 v1, v[36:39] offset:41024
    v_cvt_pk_bf16_f32 v40, v160, v161
    v_cvt_pk_bf16_f32 v41, v162, v163
    v_cvt_pk_bf16_f32 v42, v164, v165
    v_cvt_pk_bf16_f32 v43, v166, v167
    ds_write_b128 v1, v[40:43] offset:45312
    v_cvt_pk_bf16_f32 v44, v168, v169
    v_cvt_pk_bf16_f32 v45, v170, v171
    v_cvt_pk_bf16_f32 v46, v172, v173
    v_cvt_pk_bf16_f32 v47, v174, v175
    ds_write_b128 v1, v[44:47] offset:45376
    v_cvt_pk_bf16_f32 v32, v176, v177
    v_cvt_pk_bf16_f32 v33, v178, v179
    v_cvt_pk_bf16_f32 v34, v180, v181
    v_cvt_pk_bf16_f32 v35, v182, v183
    ds_write_b128 v1, v[32:35] offset:49664
    v_cvt_pk_bf16_f32 v36, v184, v185
    v_cvt_pk_bf16_f32 v37, v186, v187
    v_cvt_pk_bf16_f32 v38, v188, v189
    v_cvt_pk_bf16_f32 v39, v190, v191
    ds_write_b128 v1, v[36:39] offset:49728
    v_cvt_pk_bf16_f32 v40, v192, v193
    v_cvt_pk_bf16_f32 v41, v194, v195
    v_cvt_pk_bf16_f32 v42, v196, v197
    v_cvt_pk_bf16_f32 v43, v198, v199
    ds_write_b128 v1, v[40:43] offset:54016
    v_cvt_pk_bf16_f32 v44, v200, v201
    v_cvt_pk_bf16_f32 v45, v202, v203
    v_cvt_pk_bf16_f32 v46, v204, v205
    v_cvt_pk_bf16_f32 v47, v206, v207
    ds_write_b128 v1, v[44:47] offset:54080
    v_cvt_pk_bf16_f32 v32, v208, v209
    v_cvt_pk_bf16_f32 v33, v210, v211
    v_cvt_pk_bf16_f32 v34, v212, v213
    v_cvt_pk_bf16_f32 v35, v214, v215
    ds_write_b128 v1, v[32:35] offset:58368
    v_cvt_pk_bf16_f32 v36, v216, v217
    v_cvt_pk_bf16_f32 v37, v218, v219
    v_cvt_pk_bf16_f32 v38, v220, v221
    v_cvt_pk_bf16_f32 v39, v222, v223
    ds_write_b128 v1, v[36:39] offset:58432
    s_cmp_lg_u32 s30, 0
    s_cbranch_scc1 P1_NOGATE_ST
    v_lshlrev_b32 v1, 2, v3
    s_lshl_b32 s40, s28, 9
    s_lshl_b32 s41, s31, 8
    s_add_u32 s40, s40, s41
    s_add_u32 s40, s40, 10485760
    s_mov_b32 s60, 0xbfb8aa3b
    v_mul_f32 v224, s60, v224
    v_mul_f32 v228, s60, v228
    v_mul_f32 v232, s60, v232
    v_mul_f32 v236, s60, v236
    v_exp_f32 v224, v224
    v_exp_f32 v228, v228
    v_exp_f32 v232, v232
    v_exp_f32 v236, v236
    v_add_f32 v224, 1.0, v224
    v_add_f32 v228, 1.0, v228
    v_add_f32 v232, 1.0, v232
    v_add_f32 v236, 1.0, v236
    v_rcp_f32 v224, v224
    v_rcp_f32 v228, v228
    v_rcp_f32 v232, v232
    v_rcp_f32 v236, v236
    s_mov_b64 exec, 0xffff
    buffer_store_dword v224, v1, s[36:39], s40 offen offset:0 sc1
    buffer_store_dword v228, v1, s[36:39], s40 offen offset:64 sc1
    buffer_store_dword v232, v1, s[36:39], s40 offen offset:128 sc1
    buffer_store_dword v236, v1, s[36:39], s40 offen offset:192 sc1
    s_mov_b64 exec, -1
P1_NOGATE_ST:
    s_branch P1_STORE
P1_V2:
    ds_read_b128 v[16:19], v12 offset:0
    ds_read_b128 v[20:23], v12 offset:2048
    ds_read_b128 v[24:27], v12 offset:4096
    ds_read_b128 v[28:31], v12 offset:6144
    ds_read_b64_tr_b16 v[32:33], v14 offset:0
    ds_read_b64_tr_b16 v[34:35], v14 offset:3840
    ds_read_b64_tr_b16 v[36:37], v14 offset:8
    ds_read_b64_tr_b16 v[38:39], v14 offset:3848
    ds_read_b64_tr_b16 v[40:41], v14 offset:16
    ds_read_b64_tr_b16 v[42:43], v14 offset:3856
    ds_read_b64_tr_b16 v[44:45], v14 offset:24
    ds_read_b64_tr_b16 v[46:47], v14 offset:3864
    ds_read_b64_tr_b16 v[48:49], v14 offset:32
    ds_read_b64_tr_b16 v[50:51], v14 offset:3872
    ds_read_b64_tr_b16 v[52:53], v15 offset:160
    ds_read_b64_tr_b16 v[54:55], v15 offset:4000
    ds_read_b64_tr_b16 v[56:57], v15 offset:200
    ds_read_b64_tr_b16 v[58:59], v15 offset:4040
    ds_read_b64_tr_b16 v[60:61], v15 offset:240
    ds_read_b64_tr_b16 v[62:63], v15 offset:4080
    ds_read_b128 v[240:243], v244
    s_mov_b32 s35, 3
    s_mov_b32 s41, 2
    v_mov_b32 v1, 1
    s_mov_b32 s33, 0
    s_waitcnt lgkmcnt(0)
    ds_write_b32 v245, v1
P1_V2_LOOP:
    v_mfma_f32_16x16x32_bf16 v[112:115], v[32:35], v[16:19], v[112:115]
    v_min3_u32 v1, v240, v241, v242
    v_min_u32 v1, v1, v243
    v_mfma_f32_16x16x32_bf16 v[116:119], v[32:35], v[20:23], v[116:119]
    v_readfirstlane_b32 s40, v1
    v_mfma_f32_16x16x32_bf16 v[120:123], v[32:35], v[24:27], v[120:123]
    s_nop 0
    s_cmp_lt_u32 s40, s35
    s_cbranch_scc1 P1_V2_A_SPIN
P1_V2_A_GO:
    ds_read_b128 v[64:67], v13 offset:0
    v_mfma_f32_16x16x32_bf16 v[124:127], v[32:35], v[28:31], v[124:127]
    ds_read_b64_tr_b16 v[80:81], v14 offset:15360
    v_mfma_f32_16x16x32_bf16 v[128:131], v[36:39], v[16:19], v[128:131]
    ds_read_b128 v[68:71], v13 offset:2048
    v_mfma_f32_16x16x32_bf16 v[132:135], v[36:39], v[20:23], v[132:135]
    ds_read_b64_tr_b16 v[82:83], v14 offset:19200
    v_mfma_f32_16x16x32_bf16 v[136:139], v[36:39], v[24:27], v[136:139]
    ds_read_b128 v[72:75], v13 offset:4096
    v_mfma_f32_16x16x32_bf16 v[140:143], v[36:39], v[28:31], v[140:143]
    ds_read_b64_tr_b16 v[84:85], v14 offset:15368
    v_mfma_f32_16x16x32_bf16 v[144:147], v[40:43], v[16:19], v[144:147]
    ds_read_b128 v[76:79], v13 offset:6144
    v_mfma_f32_16x16x32_bf16 v[148:151], v[40:43], v[20:23], v[148:151]
    ds_read_b64_tr_b16 v[86:87], v14 offset:19208
    v_mfma_f32_16x16x32_bf16 v[152:155], v[40:43], v[24:27], v[152:155]
    ds_read_b64_tr_b16 v[88:89], v14 offset:15376
    v_mfma_f32_16x16x32_bf16 v[156:159], v[40:43], v[28:31], v[156:159]
    ds_read_b64_tr_b16 v[90:91], v14 offset:19216
    v_mfma_f32_16x16x32_bf16 v[160:163], v[44:47], v[16:19], v[160:163]
    ds_read_b64_tr_b16 v[92:93], v14 offset:15384
    v_mfma_f32_16x16x32_bf16 v[164:167], v[44:47], v[20:23], v[164:167]
    ds_read_b64_tr_b16 v[94:95], v14 offset:19224
    v_mfma_f32_16x16x32_bf16 v[168:171], v[44:47], v[24:27], v[168:171]
    ds_read_b64_tr_b16 v[96:97], v14 offset:15392
    v_mfma_f32_16x16x32_bf16 v[172:175], v[44:47], v[28:31], v[172:175]
    ds_read_b64_tr_b16 v[98:99], v14 offset:19232
    v_mfma_f32_16x16x32_bf16 v[176:179], v[48:51], v[16:19], v[176:179]
    ds_read_b64_tr_b16 v[100:101], v15 offset:15520
    v_mfma_f32_16x16x32_bf16 v[180:183], v[48:51], v[20:23], v[180:183]
    ds_read_b64_tr_b16 v[102:103], v15 offset:19360
    v_mfma_f32_16x16x32_bf16 v[184:187], v[48:51], v[24:27], v[184:187]
    ds_read_b64_tr_b16 v[104:105], v15 offset:15560
    v_mfma_f32_16x16x32_bf16 v[188:191], v[48:51], v[28:31], v[188:191]
    ds_read_b64_tr_b16 v[106:107], v15 offset:19400
    v_mfma_f32_16x16x32_bf16 v[192:195], v[16:19], v[52:55], v[192:195]
    ds_read_b64_tr_b16 v[108:109], v15 offset:15600
    v_mfma_f32_16x16x32_bf16 v[196:199], v[20:23], v[52:55], v[196:199]
    ds_read_b64_tr_b16 v[110:111], v15 offset:19440
    v_mfma_f32_16x16x32_bf16 v[200:203], v[24:27], v[52:55], v[200:203]
    ds_read_b128 v[240:243], v244
    v_mfma_f32_16x16x32_bf16 v[204:207], v[28:31], v[52:55], v[204:207]
    v_mfma_f32_16x16x32_bf16 v[208:211], v[16:19], v[56:59], v[208:211]
    v_mfma_f32_16x16x32_bf16 v[212:215], v[20:23], v[56:59], v[212:215]
    v_mfma_f32_16x16x32_bf16 v[216:219], v[24:27], v[56:59], v[216:219]
    v_mfma_f32_16x16x32_bf16 v[220:223], v[28:31], v[56:59], v[220:223]
    v_mfma_f32_16x16x32_bf16 v[224:227], v[16:19], v[60:63], v[224:227]
    v_mfma_f32_16x16x32_bf16 v[228:231], v[20:23], v[60:63], v[228:231]
    v_mfma_f32_16x16x32_bf16 v[232:235], v[24:27], v[60:63], v[232:235]
    v_mfma_f32_16x16x32_bf16 v[236:239], v[28:31], v[60:63], v[236:239]
    v_mov_b32 v1, s41
    s_add_u32 s41, s41, 1
    s_add_u32 s35, s35, 2
    s_min_u32 s35, s35, 30
    s_waitcnt lgkmcnt(0)
    ds_write_b32 v245, v1
    v_mfma_f32_16x16x32_bf16 v[112:115], v[80:83], v[64:67], v[112:115]
    v_min3_u32 v1, v240, v241, v242
    v_min_u32 v1, v1, v243
    v_mfma_f32_16x16x32_bf16 v[116:119], v[80:83], v[68:71], v[116:119]
    v_readfirstlane_b32 s40, v1
    s_add_u32 s34, s34, 47104
    s_cmp_eq_u32 s34, 141312
    s_cselect_b32 s34, 0, s34
    v_add_u32 v12, s34, v8
    v_add_u32 v13, s34, v9
    v_add_u32 v14, s34, v10
    v_add_u32 v15, s34, v11
    v_mfma_f32_16x16x32_bf16 v[120:123], v[80:83], v[72:75], v[120:123]
    s_cmp_lt_u32 s40, s35
    s_cbranch_scc1 P1_V2_B_SPIN
P1_V2_B_GO:
    ds_read_b128 v[16:19], v12 offset:0
    v_mfma_f32_16x16x32_bf16 v[124:127], v[80:83], v[76:79], v[124:127]
    ds_read_b64_tr_b16 v[32:33], v14 offset:0
    v_mfma_f32_16x16x32_bf16 v[128:131], v[84:87], v[64:67], v[128:131]
    ds_read_b128 v[20:23], v12 offset:2048
    v_mfma_f32_16x16x32_bf16 v[132:135], v[84:87], v[68:71], v[132:135]
    ds_read_b64_tr_b16 v[34:35], v14 offset:3840
    v_mfma_f32_16x16x32_bf16 v[136:139], v[84:87], v[72:75], v[136:139]
    ds_read_b128 v[24:27], v12 offset:4096
    v_mfma_f32_16x16x32_bf16 v[140:143], v[84:87], v[76:79], v[140:143]
    ds_read_b64_tr_b16 v[36:37], v14 offset:8
    v_mfma_f32_16x16x32_bf16 v[144:147], v[88:91], v[64:67], v[144:147]
    ds_read_b128 v[28:31], v12 offset:6144
    v_mfma_f32_16x16x32_bf16 v[148:151], v[88:91], v[68:71], v[148:151]
    ds_read_b64_tr_b16 v[38:39], v14 offset:3848
    v_mfma_f32_16x16x32_bf16 v[152:155], v[88:91], v[72:75], v[152:155]
    ds_read_b64_tr_b16 v[40:41], v14 offset:16
    v_mfma_f32_16x16x32_bf16 v[156:159], v[88:91], v[76:79], v[156:159]
    ds_read_b64_tr_b16 v[42:43], v14 offset:3856
    v_mfma_f32_16x16x32_bf16 v[160:163], v[92:95], v[64:67], v[160:163]
    ds_read_b64_tr_b16 v[44:45], v14 offset:24
    v_mfma_f32_16x16x32_bf16 v[164:167], v[92:95], v[68:71], v[164:167]
    ds_read_b64_tr_b16 v[46:47], v14 offset:3864
    v_mfma_f32_16x16x32_bf16 v[168:171], v[92:95], v[72:75], v[168:171]
    ds_read_b64_tr_b16 v[48:49], v14 offset:32
    v_mfma_f32_16x16x32_bf16 v[172:175], v[92:95], v[76:79], v[172:175]
    ds_read_b64_tr_b16 v[50:51], v14 offset:3872
    v_mfma_f32_16x16x32_bf16 v[176:179], v[96:99], v[64:67], v[176:179]
    ds_read_b64_tr_b16 v[52:53], v15 offset:160
    v_mfma_f32_16x16x32_bf16 v[180:183], v[96:99], v[68:71], v[180:183]
    ds_read_b64_tr_b16 v[54:55], v15 offset:4000
    v_mfma_f32_16x16x32_bf16 v[184:187], v[96:99], v[72:75], v[184:187]
    ds_read_b64_tr_b16 v[56:57], v15 offset:200
    v_mfma_f32_16x16x32_bf16 v[188:191], v[96:99], v[76:79], v[188:191]
    ds_read_b64_tr_b16 v[58:59], v15 offset:4040
    v_mfma_f32_16x16x32_bf16 v[192:195], v[64:67], v[100:103], v[192:195]
    ds_read_b64_tr_b16 v[60:61], v15 offset:240
    v_mfma_f32_16x16x32_bf16 v[196:199], v[68:71], v[100:103], v[196:199]
    ds_read_b64_tr_b16 v[62:63], v15 offset:4080
    v_mfma_f32_16x16x32_bf16 v[200:203], v[72:75], v[100:103], v[200:203]
    ds_read_b128 v[240:243], v244
    v_mfma_f32_16x16x32_bf16 v[204:207], v[76:79], v[100:103], v[204:207]
    v_mfma_f32_16x16x32_bf16 v[208:211], v[64:67], v[104:107], v[208:211]
    v_mfma_f32_16x16x32_bf16 v[212:215], v[68:71], v[104:107], v[212:215]
    v_mfma_f32_16x16x32_bf16 v[216:219], v[72:75], v[104:107], v[216:219]
    v_mfma_f32_16x16x32_bf16 v[220:223], v[76:79], v[104:107], v[220:223]
    v_mfma_f32_16x16x32_bf16 v[224:227], v[64:67], v[108:111], v[224:227]
    v_mfma_f32_16x16x32_bf16 v[228:231], v[68:71], v[108:111], v[228:231]
    v_mfma_f32_16x16x32_bf16 v[232:235], v[72:75], v[108:111], v[232:235]
    v_mfma_f32_16x16x32_bf16 v[236:239], v[76:79], v[108:111], v[236:239]
    v_mov_b32 v1, s41
    s_add_u32 s41, s41, 1
    s_add_u32 s35, s35, 1
    s_min_u32 s35, s35, 30
    s_waitcnt lgkmcnt(0)
    ds_write_b32 v245, v1
    s_add_u32 s33, s33, 1
    s_cmp_lt_u32 s33, 10
    s_cbranch_scc1 P1_V2_LOOP
    s_setprio 0
    s_lshl_b32 s40, s31, 6
    v_lshl_add_u32 v1, v4, 7, v3
    v_add_u32 v1, s40, v1
    v_mul_u32_u24 v1, 40, v1
    s_mov_b32 s60, 0x3fb8aa3b
    s_mov_b32 s61, 0x3fb8aa3b
    s_mov_b32 s62, 1.0
    s_mov_b32 s63, 1.0
    s_mov_b32 s64, 0x358637bd
    s_mov_b32 s65, 0x358637bd
    v_pk_mul_f32 v[64:65], v[192:193], s[60:61]
    v_pk_mul_f32 v[66:67], v[194:195], s[60:61]
    v_pk_mul_f32 v[68:69], v[196:197], s[60:61]
    v_pk_mul_f32 v[70:71], v[198:199], s[60:61]
    v_exp_f32 v64, v64
    v_exp_f32 v65, v65
    v_exp_f32 v66, v66
    v_exp_f32 v67, v67
    v_exp_f32 v68, v68
    v_exp_f32 v69, v69
    v_exp_f32 v70, v70
    v_exp_f32 v71, v71
    v_pk_add_f32 v[192:193], v[192:193], s[62:63]
    v_pk_add_f32 v[194:195], v[194:195], s[62:63]
    v_pk_add_f32 v[196:197], v[196:197], s[62:63]
    v_pk_add_f32 v[198:199], v[198:199], s[62:63]
    v_med3_f32 v192, v64, v192, 1.0
    v_med3_f32 v193, v65, v193, 1.0
    v_med3_f32 v194, v66, v194, 1.0
    v_med3_f32 v195, v67, v195, 1.0
    v_med3_f32 v196, v68, v196, 1.0
    v_med3_f32 v197, v69, v197, 1.0
    v_med3_f32 v198, v70, v198, 1.0
    v_med3_f32 v199, v71, v199, 1.0
    v_pk_add_f32 v[192:193], v[192:193], s[64:65]
    v_pk_add_f32 v[194:195], v[194:195], s[64:65]
    v_pk_add_f32 v[196:197], v[196:197], s[64:65]
    v_pk_add_f32 v[198:199], v[198:199], s[64:65]
    v_pk_mul_f32 v[64:65], v[200:201], s[60:61]
    v_pk_mul_f32 v[66:67], v[202:203], s[60:61]
    v_pk_mul_f32 v[68:69], v[204:205], s[60:61]
    v_pk_mul_f32 v[70:71], v[206:207], s[60:61]
    v_exp_f32 v64, v64
    v_exp_f32 v65, v65
    v_exp_f32 v66, v66
    v_exp_f32 v67, v67
    v_exp_f32 v68, v68
    v_exp_f32 v69, v69
    v_exp_f32 v70, v70
    v_exp_f32 v71, v71
    v_pk_add_f32 v[200:201], v[200:201], s[62:63]
    v_pk_add_f32 v[202:203], v[202:203], s[62:63]
    v_pk_add_f32 v[204:205], v[204:205], s[62:63]
    v_pk_add_f32 v[206:207], v[206:207], s[62:63]
    v_med3_f32 v200, v64, v200, 1.0
    v_med3_f32 v201, v65, v201, 1.0
    v_med3_f32 v202, v66, v202, 1.0
    v_med3_f32 v203, v67, v203, 1.0
    v_med3_f32 v204, v68, v204, 1.0
    v_med3_f32 v205, v69, v205, 1.0
    v_med3_f32 v206, v70, v206, 1.0
    v_med3_f32 v207, v71, v207, 1.0
    v_pk_add_f32 v[200:201], v[200:201], s[64:65]
    v_pk_add_f32 v[202:203], v[202:203], s[64:65]
    v_pk_add_f32 v[204:205], v[204:205], s[64:65]
    v_pk_add_f32 v[206:207], v[206:207], s[64:65]
    v_pk_mul_f32 v[64:65], v[208:209], s[60:61]
    v_pk_mul_f32 v[66:67], v[210:211], s[60:61]
    v_pk_mul_f32 v[68:69], v[212:213], s[60:61]
    v_pk_mul_f32 v[70:71], v[214:215], s[60:61]
    v_exp_f32 v64, v64
    v_exp_f32 v65, v65
    v_exp_f32 v66, v66
    v_exp_f32 v67, v67
    v_exp_f32 v68, v68
    v_exp_f32 v69, v69
    v_exp_f32 v70, v70
    v_exp_f32 v71, v71
    v_pk_add_f32 v[208:209], v[208:209], s[62:63]
    v_pk_add_f32 v[210:211], v[210:211], s[62:63]
    v_pk_add_f32 v[212:213], v[212:213], s[62:63]
    v_pk_add_f32 v[214:215], v[214:215], s[62:63]
    v_med3_f32 v208, v64, v208, 1.0
    v_med3_f32 v209, v65, v209, 1.0
    v_med3_f32 v210, v66, v210, 1.0
    v_med3_f32 v211, v67, v211, 1.0
    v_med3_f32 v212, v68, v212, 1.0
    v_med3_f32 v213, v69, v213, 1.0
    v_med3_f32 v214, v70, v214, 1.0
    v_med3_f32 v215, v71, v215, 1.0
    v_pk_add_f32 v[208:209], v[208:209], s[64:65]
    v_pk_add_f32 v[210:211], v[210:211], s[64:65]
    v_pk_add_f32 v[212:213], v[212:213], s[64:65]
    v_pk_add_f32 v[214:215], v[214:215], s[64:65]
    v_pk_mul_f32 v[64:65], v[216:217], s[60:61]
    v_pk_mul_f32 v[66:67], v[218:219], s[60:61]
    v_pk_mul_f32 v[68:69], v[220:221], s[60:61]
    v_pk_mul_f32 v[70:71], v[222:223], s[60:61]
    v_exp_f32 v64, v64
    v_exp_f32 v65, v65
    v_exp_f32 v66, v66
    v_exp_f32 v67, v67
    v_exp_f32 v68, v68
    v_exp_f32 v69, v69
    v_exp_f32 v70, v70
    v_exp_f32 v71, v71
    v_pk_add_f32 v[216:217], v[216:217], s[62:63]
    v_pk_add_f32 v[218:219], v[218:219], s[62:63]
    v_pk_add_f32 v[220:221], v[220:221], s[62:63]
    v_pk_add_f32 v[222:223], v[222:223], s[62:63]
    v_med3_f32 v216, v64, v216, 1.0
    v_med3_f32 v217, v65, v217, 1.0
    v_med3_f32 v218, v66, v218, 1.0
    v_med3_f32 v219, v67, v219, 1.0
    v_med3_f32 v220, v68, v220, 1.0
    v_med3_f32 v221, v69, v221, 1.0
    v_med3_f32 v222, v70, v222, 1.0
    v_med3_f32 v223, v71, v223, 1.0
    v_pk_add_f32 v[216:217], v[216:217], s[64:65]
    v_pk_add_f32 v[218:219], v[218:219], s[64:65]
    v_pk_add_f32 v[220:221], v[220:221], s[64:65]
    v_pk_add_f32 v[222:223], v[222:223], s[64:65]
    v_pk_mul_f32 v[64:65], v[224:225], s[60:61]
    v_pk_mul_f32 v[66:67], v[226:227], s[60:61]
    v_pk_mul_f32 v[68:69], v[228:229], s[60:61]
    v_pk_mul_f32 v[70:71], v[230:231], s[60:61]
    v_exp_f32 v64, v64
    v_exp_f32 v65, v65
    v_exp_f32 v66, v66
    v_exp_f32 v67, v67
    v_exp_f32 v68, v68
    v_exp_f32 v69, v69
    v_exp_f32 v70, v70
    v_exp_f32 v71, v71
    v_pk_add_f32 v[224:225], v[224:225], s[62:63]
    v_pk_add_f32 v[226:227], v[226:227], s[62:63]
    v_pk_add_f32 v[228:229], v[228:229], s[62:63]
    v_pk_add_f32 v[230:231], v[230:231], s[62:63]
    v_med3_f32 v224, v64, v224, 1.0
    v_med3_f32 v225, v65, v225, 1.0
    v_med3_f32 v226, v66, v226, 1.0
    v_med3_f32 v227, v67, v227, 1.0
    v_med3_f32 v228, v68, v228, 1.0
    v_med3_f32 v229, v69, v229, 1.0
    v_med3_f32 v230, v70, v230, 1.0
    v_med3_f32 v231, v71, v231, 1.0
    v_pk_add_f32 v[224:225], v[224:225], s[64:65]
    v_pk_add_f32 v[226:227], v[226:227], s[64:65]
    v_pk_add_f32 v[228:229], v[228:229], s[64:65]
    v_pk_add_f32 v[230:231], v[230:231], s[64:65]
    v_pk_mul_f32 v[64:65], v[232:233], s[60:61]
    v_pk_mul_f32 v[66:67], v[234:235], s[60:61]
    v_pk_mul_f32 v[68:69], v[236:237], s[60:61]
    v_pk_mul_f32 v[70:71], v[238:239], s[60:61]
    v_exp_f32 v64, v64
    v_exp_f32 v65, v65
    v_exp_f32 v66, v66
    v_exp_f32 v67, v67
    v_exp_f32 v68, v68
    v_exp_f32 v69, v69
    v_exp_f32 v70, v70
    v_exp_f32 v71, v71
    v_pk_add_f32 v[232:233], v[232:233], s[62:63]
    v_pk_add_f32 v[234:235], v[234:235], s[62:63]
    v_pk_add_f32 v[236:237], v[236:237], s[62:63]
    v_pk_add_f32 v[238:239], v[238:239], s[62:63]
    v_med3_f32 v232, v64, v232, 1.0
    v_med3_f32 v233, v65, v233, 1.0
    v_med3_f32 v234, v66, v234, 1.0
    v_med3_f32 v235, v67, v235, 1.0
    v_med3_f32 v236, v68, v236, 1.0
    v_med3_f32 v237, v69, v237, 1.0
    v_med3_f32 v238, v70, v238, 1.0
    v_med3_f32 v239, v71, v239, 1.0
    v_pk_add_f32 v[232:233], v[232:233], s[64:65]
    v_pk_add_f32 v[234:235], v[234:235], s[64:65]
    v_pk_add_f32 v[236:237], v[236:237], s[64:65]
    v_pk_add_f32 v[238:239], v[238:239], s[64:65]
    s_waitcnt lgkmcnt(0)
    s_barrier
    s_lshl_b32 s40, s31, 11
    s_add_u32 s40, s40, 65536
    v_add_u32 v7, s40, v246
    v_cvt_pk_bf16_f32 v80, v192, v193
    v_cvt_pk_bf16_f32 v81, v194, v195
    v_cvt_pk_bf16_f32 v82, v196, v197
    v_cvt_pk_bf16_f32 v83, v198, v199
    ds_write_b128 v7, v[80:83] offset:0
    v_cvt_pk_bf16_f32 v84, v200, v201
    v_cvt_pk_bf16_f32 v85, v202, v203
    v_cvt_pk_bf16_f32 v86, v204, v205
    v_cvt_pk_bf16_f32 v87, v206, v207
    ds_write_b128 v7, v[84:87] offset:1024
    v_cvt_pk_bf16_f32 v88, v208, v209
    v_cvt_pk_bf16_f32 v89, v210, v211
    v_cvt_pk_bf16_f32 v90, v212, v213
    v_cvt_pk_bf16_f32 v91, v214, v215
    ds_write_b128 v7, v[88:91] offset:4096
    v_cvt_pk_bf16_f32 v92, v216, v217
    v_cvt_pk_bf16_f32 v93, v218, v219
    v_cvt_pk_bf16_f32 v94, v220, v221
    v_cvt_pk_bf16_f32 v95, v222, v223
    ds_write_b128 v7, v[92:95] offset:5120
    v_cvt_pk_bf16_f32 v80, v224, v225
    v_cvt_pk_bf16_f32 v81, v226, v227
    v_cvt_pk_bf16_f32 v82, v228, v229
    v_cvt_pk_bf16_f32 v83, v230, v231
    ds_write_b128 v7, v[80:83] offset:8192
    v_cvt_pk_bf16_f32 v84, v232, v233
    v_cvt_pk_bf16_f32 v85, v234, v235
    v_cvt_pk_bf16_f32 v86, v236, v237
    v_cvt_pk_bf16_f32 v87, v238, v239
    ds_write_b128 v7, v[84:87] offset:9216
    v_cvt_pk_bf16_f32 v16, v112, v113
    v_cvt_pk_bf16_f32 v17, v114, v115
    ds_write_b64 v1, v[16:17] offset:0
    v_cvt_pk_bf16_f32 v18, v128, v129
    v_cvt_pk_bf16_f32 v19, v130, v131
    ds_write_b64 v1, v[18:19] offset:8
    v_cvt_pk_bf16_f32 v20, v144, v145
    v_cvt_pk_bf16_f32 v21, v146, v147
    ds_write_b64 v1, v[20:21] offset:16
    v_cvt_pk_bf16_f32 v22, v160, v161
    v_cvt_pk_bf16_f32 v23, v162, v163
    ds_write_b64 v1, v[22:23] offset:24
    v_cvt_pk_bf16_f32 v24, v176, v177
    v_cvt_pk_bf16_f32 v25, v178, v179
    ds_write_b64 v1, v[24:25] offset:32
    v_cvt_pk_bf16_f32 v26, v116, v117
    v_cvt_pk_bf16_f32 v27, v118, v119
    ds_write_b64 v1, v[26:27] offset:640
    v_cvt_pk_bf16_f32 v28, v132, v133
    v_cvt_pk_bf16_f32 v29, v134, v135
    ds_write_b64 v1, v[28:29] offset:648
    v_cvt_pk_bf16_f32 v30, v148, v149
    v_cvt_pk_bf16_f32 v31, v150, v151
    ds_write_b64 v1, v[30:31] offset:656
    v_cvt_pk_bf16_f32 v16, v164, v165
    v_cvt_pk_bf16_f32 v17, v166, v167
    ds_write_b64 v1, v[16:17] offset:664
    v_cvt_pk_bf16_f32 v18, v180, v181
    v_cvt_pk_bf16_f32 v19, v182, v183
    ds_write_b64 v1, v[18:19] offset:672
    v_cvt_pk_bf16_f32 v20, v120, v121
    v_cvt_pk_bf16_f32 v21, v122, v123
    ds_write_b64 v1, v[20:21] offset:1280
    v_cvt_pk_bf16_f32 v22, v136, v137
    v_cvt_pk_bf16_f32 v23, v138, v139
    ds_write_b64 v1, v[22:23] offset:1288
    v_cvt_pk_bf16_f32 v24, v152, v153
    v_cvt_pk_bf16_f32 v25, v154, v155
    ds_write_b64 v1, v[24:25] offset:1296
    v_cvt_pk_bf16_f32 v26, v168, v169
    v_cvt_pk_bf16_f32 v27, v170, v171
    ds_write_b64 v1, v[26:27] offset:1304
    v_cvt_pk_bf16_f32 v28, v184, v185
    v_cvt_pk_bf16_f32 v29, v186, v187
    ds_write_b64 v1, v[28:29] offset:1312
    v_cvt_pk_bf16_f32 v30, v124, v125
    v_cvt_pk_bf16_f32 v31, v126, v127
    ds_write_b64 v1, v[30:31] offset:1920
    v_cvt_pk_bf16_f32 v16, v140, v141
    v_cvt_pk_bf16_f32 v17, v142, v143
    ds_write_b64 v1, v[16:17] offset:1928
    v_cvt_pk_bf16_f32 v18, v156, v157
    v_cvt_pk_bf16_f32 v19, v158, v159
    ds_write_b64 v1, v[18:19] offset:1936
    v_cvt_pk_bf16_f32 v20, v172, v173
    v_cvt_pk_bf16_f32 v21, v174, v175
    ds_write_b64 v1, v[20:21] offset:1944
    v_cvt_pk_bf16_f32 v22, v188, v189
    v_cvt_pk_bf16_f32 v23, v190, v191
    ds_write_b64 v1, v[22:23] offset:1952
    s_branch P1_STORE
P1_V3:
    ds_read_b128 v[16:19], v12 offset:0
    ds_read_b128 v[20:23], v12 offset:2048
    ds_read_b128 v[24:27], v12 offset:4096
    ds_read_b128 v[28:31], v12 offset:6144
    ds_read_b64_tr_b16 v[32:33], v15 offset:280
    ds_read_b64_tr_b16 v[34:35], v15 offset:4120
    ds_read_b64_tr_b16 v[36:37], v14 offset:192
    ds_read_b64_tr_b16 v[38:39], v14 offset:4032
    ds_read_b64_tr_b16 v[40:41], v15 offset:320
    ds_read_b64_tr_b16 v[42:43], v15 offset:4160
    ds_read_b64_tr_b16 v[44:45], v15 offset:360
    ds_read_b64_tr_b16 v[46:47], v15 offset:4200
    ds_read_b64_tr_b16 v[48:49], v15 offset:400
    ds_read_b64_tr_b16 v[50:51], v15 offset:4240
    ds_read_b64_tr_b16 v[52:53], v15 offset:440
    ds_read_b64_tr_b16 v[54:55], v15 offset:4280
    ds_read_b64_tr_b16 v[56:57], v14 offset:352
    ds_read_b64_tr_b16 v[58:59], v14 offset:4192
    ds_read_b128 v[240:243], v244
    s_mov_b32 s35, 3
    s_mov_b32 s41, 2
    v_mov_b32 v1, 1
    s_mov_b32 s33, 0
    s_waitcnt lgkmcnt(0)
    ds_write_b32 v245, v1
P1_V3_LOOP:
    v_mfma_f32_16x16x32_bf16 v[112:115], v[16:19], v[32:35], v[112:115]
    v_min3_u32 v1, v240, v241, v242
    v_min_u32 v1, v1, v243
    v_mfma_f32_16x16x32_bf16 v[116:119], v[20:23], v[32:35], v[116:119]
    v_readfirstlane_b32 s40, v1
    v_mfma_f32_16x16x32_bf16 v[120:123], v[24:27], v[32:35], v[120:123]
    s_nop 0
    s_cmp_lt_u32 s40, s35
    s_cbranch_scc1 P1_V3_A_SPIN
P1_V3_A_GO:
    ds_read_b128 v[64:67], v13 offset:0
    v_mfma_f32_16x16x32_bf16 v[124:127], v[28:31], v[32:35], v[124:127]
    ds_read_b64_tr_b16 v[80:81], v15 offset:15640
    v_mfma_f32_16x16x32_bf16 v[128:131], v[16:19], v[36:39], v[128:131]
    ds_read_b128 v[68:71], v13 offset:2048
    v_mfma_f32_16x16x32_bf16 v[132:135], v[20:23], v[36:39], v[132:135]
    ds_read_b64_tr_b16 v[82:83], v15 offset:19480
    v_mfma_f32_16x16x32_bf16 v[136:139], v[24:27], v[36:39], v[136:139]
    ds_read_b128 v[72:75], v13 offset:4096
    v_mfma_f32_16x16x32_bf16 v[140:143], v[28:31], v[36:39], v[140:143]
    ds_read_b64_tr_b16 v[84:85], v14 offset:15552
    v_mfma_f32_16x16x32_bf16 v[144:147], v[16:19], v[40:43], v[144:147]
    ds_read_b128 v[76:79], v13 offset:6144
    v_mfma_f32_16x16x32_bf16 v[148:151], v[20:23], v[40:43], v[148:151]
    ds_read_b64_tr_b16 v[86:87], v14 offset:19392
    v_mfma_f32_16x16x32_bf16 v[152:155], v[24:27], v[40:43], v[152:155]
    ds_read_b64_tr_b16 v[88:89], v15 offset:15680
    v_mfma_f32_16x16x32_bf16 v[156:159], v[28:31], v[40:43], v[156:159]
    ds_read_b64_tr_b16 v[90:91], v15 offset:19520
    v_mfma_f32_16x16x32_bf16 v[160:163], v[16:19], v[44:47], v[160:163]
    ds_read_b64_tr_b16 v[92:93], v15 offset:15720
    v_mfma_f32_16x16x32_bf16 v[164:167], v[20:23], v[44:47], v[164:167]
    ds_read_b64_tr_b16 v[94:95], v15 offset:19560
    v_mfma_f32_16x16x32_bf16 v[168:171], v[24:27], v[44:47], v[168:171]
    ds_read_b64_tr_b16 v[96:97], v15 offset:15760
    v_mfma_f32_16x16x32_bf16 v[172:175], v[28:31], v[44:47], v[172:175]
    ds_read_b64_tr_b16 v[98:99], v15 offset:19600
    v_mfma_f32_16x16x32_bf16 v[176:179], v[16:19], v[48:51], v[176:179]
    ds_read_b64_tr_b16 v[100:101], v15 offset:15800
    v_mfma_f32_16x16x32_bf16 v[180:183], v[20:23], v[48:51], v[180:183]
    ds_read_b64_tr_b16 v[102:103], v15 offset:19640
    v_mfma_f32_16x16x32_bf16 v[184:187], v[24:27], v[48:51], v[184:187]
    ds_read_b64_tr_b16 v[104:105], v14 offset:15712
    v_mfma_f32_16x16x32_bf16 v[188:191], v[28:31], v[48:51], v[188:191]
    ds_read_b64_tr_b16 v[106:107], v14 offset:19552
    v_mfma_f32_16x16x32_bf16 v[192:195], v[16:19], v[52:55], v[192:195]
    ds_read_b128 v[240:243], v244
    v_mfma_f32_16x16x32_bf16 v[196:199], v[20:23], v[52:55], v[196:199]
    v_mfma_f32_16x16x32_bf16 v[200:203], v[24:27], v[52:55], v[200:203]
    v_mfma_f32_16x16x32_bf16 v[204:207], v[28:31], v[52:55], v[204:207]
    v_mfma_f32_16x16x32_bf16 v[208:211], v[16:19], v[56:59], v[208:211]
    v_mfma_f32_16x16x32_bf16 v[212:215], v[20:23], v[56:59], v[212:215]
    v_mfma_f32_16x16x32_bf16 v[216:219], v[24:27], v[56:59], v[216:219]
    v_mfma_f32_16x16x32_bf16 v[220:223], v[28:31], v[56:59], v[220:223]
    v_mov_b32 v1, s41
    s_add_u32 s41, s41, 1
    s_add_u32 s35, s35, 2
    s_min_u32 s35, s35, 30
    s_waitcnt lgkmcnt(0)
    ds_write_b32 v245, v1
    v_mfma_f32_16x16x32_bf16 v[112:115], v[64:67], v[80:83], v[112:115]
    v_min3_u32 v1, v240, v241, v242
    v_min_u32 v1, v1, v243
    v_mfma_f32_16x16x32_bf16 v[116:119], v[68:71], v[80:83], v[116:119]
    v_readfirstlane_b32 s40, v1
    s_add_u32 s34, s34, 47104
    s_cmp_eq_u32 s34, 141312
    s_cselect_b32 s34, 0, s34
    v_add_u32 v12, s34, v8
    v_add_u32 v13, s34, v9
    v_add_u32 v14, s34, v10
    v_add_u32 v15, s34, v11
    v_mfma_f32_16x16x32_bf16 v[120:123], v[72:75], v[80:83], v[120:123]
    s_cmp_lt_u32 s40, s35
    s_cbranch_scc1 P1_V3_B_SPIN
P1_V3_B_GO:
    ds_read_b128 v[16:19], v12 offset:0
    v_mfma_f32_16x16x32_bf16 v[124:127], v[76:79], v[80:83], v[124:127]
    ds_read_b64_tr_b16 v[32:33], v15 offset:280
    v_mfma_f32_16x16x32_bf16 v[128:131], v[64:67], v[84:87], v[128:131]
    ds_read_b128 v[20:23], v12 offset:2048
    v_mfma_f32_16x16x32_bf16 v[132:135], v[68:71], v[84:87], v[132:135]
    ds_read_b64_tr_b16 v[34:35], v15 offset:4120
    v_mfma_f32_16x16x32_bf16 v[136:139], v[72:75], v[84:87], v[136:139]
    ds_read_b128 v[24:27], v12 offset:4096
    v_mfma_f32_16x16x32_bf16 v[140:143], v[76:79], v[84:87], v[140:143]
    ds_read_b64_tr_b16 v[36:37], v14 offset:192
    v_mfma_f32_16x16x32_bf16 v[144:147], v[64:67], v[88:91], v[144:147]
    ds_read_b128 v[28:31], v12 offset:6144
    v_mfma_f32_16x16x32_bf16 v[148:151], v[68:71], v[88:91], v[148:151]
    ds_read_b64_tr_b16 v[38:39], v14 offset:4032
    v_mfma_f32_16x16x32_bf16 v[152:155], v[72:75], v[88:91], v[152:155]
    ds_read_b64_tr_b16 v[40:41], v15 offset:320
    v_mfma_f32_16x16x32_bf16 v[156:159], v[76:79], v[88:91], v[156:159]
    ds_read_b64_tr_b16 v[42:43], v15 offset:4160
    v_mfma_f32_16x16x32_bf16 v[160:163], v[64:67], v[92:95], v[160:163]
    ds_read_b64_tr_b16 v[44:45], v15 offset:360
    v_mfma_f32_16x16x32_bf16 v[164:167], v[68:71], v[92:95], v[164:167]
    ds_read_b64_tr_b16 v[46:47], v15 offset:4200
    v_mfma_f32_16x16x32_bf16 v[168:171], v[72:75], v[92:95], v[168:171]
    ds_read_b64_tr_b16 v[48:49], v15 offset:400
    v_mfma_f32_16x16x32_bf16 v[172:175], v[76:79], v[92:95], v[172:175]
    ds_read_b64_tr_b16 v[50:51], v15 offset:4240
    v_mfma_f32_16x16x32_bf16 v[176:179], v[64:67], v[96:99], v[176:179]
    ds_read_b64_tr_b16 v[52:53], v15 offset:440
    v_mfma_f32_16x16x32_bf16 v[180:183], v[68:71], v[96:99], v[180:183]
    ds_read_b64_tr_b16 v[54:55], v15 offset:4280
    v_mfma_f32_16x16x32_bf16 v[184:187], v[72:75], v[96:99], v[184:187]
    ds_read_b64_tr_b16 v[56:57], v14 offset:352
    v_mfma_f32_16x16x32_bf16 v[188:191], v[76:79], v[96:99], v[188:191]
    ds_read_b64_tr_b16 v[58:59], v14 offset:4192
    v_mfma_f32_16x16x32_bf16 v[192:195], v[64:67], v[100:103], v[192:195]
    ds_read_b128 v[240:243], v244
    v_mfma_f32_16x16x32_bf16 v[196:199], v[68:71], v[100:103], v[196:199]
    v_mfma_f32_16x16x32_bf16 v[200:203], v[72:75], v[100:103], v[200:203]
    v_mfma_f32_16x16x32_bf16 v[204:207], v[76:79], v[100:103], v[204:207]
    v_mfma_f32_16x16x32_bf16 v[208:211], v[64:67], v[104:107], v[208:211]
    v_mfma_f32_16x16x32_bf16 v[212:215], v[68:71], v[104:107], v[212:215]
    v_mfma_f32_16x16x32_bf16 v[216:219], v[72:75], v[104:107], v[216:219]
    v_mfma_f32_16x16x32_bf16 v[220:223], v[76:79], v[104:107], v[220:223]
    v_mov_b32 v1, s41
    s_add_u32 s41, s41, 1
    s_add_u32 s35, s35, 1
    s_min_u32 s35, s35, 30
    s_waitcnt lgkmcnt(0)
    ds_write_b32 v245, v1
    s_add_u32 s33, s33, 1
    s_cmp_lt_u32 s33, 10
    s_cbranch_scc1 P1_V3_LOOP
    s_setprio 0
    s_lshl_b32 s40, s31, 6
    v_lshl_add_u32 v1, v4, 7, v3
    v_add_u32 v1, s40, v1
    v_mul_u32_u24 v1, 40, v1
    s_mov_b32 s60, 0x3fb8aa3b
    s_mov_b32 s61, 0x3fb8aa3b
    s_mov_b32 s62, 1.0
    s_mov_b32 s63, 1.0
    s_mov_b32 s64, 0x358637bd
    s_mov_b32 s65, 0x358637bd
    v_pk_mul_f32 v[64:65], v[112:113], s[60:61]
    v_pk_mul_f32 v[66:67], v[114:115], s[60:61]
    v_pk_mul_f32 v[68:69], v[116:117], s[60:61]
    v_pk_mul_f32 v[70:71], v[118:119], s[60:61]
    v_exp_f32 v64, v64
    v_exp_f32 v65, v65
    v_exp_f32 v66, v66
    v_exp_f32 v67, v67
    v_exp_f32 v68, v68
    v_exp_f32 v69, v69
    v_exp_f32 v70, v70
    v_exp_f32 v71, v71
    v_pk_add_f32 v[112:113], v[112:113], s[62:63]
    v_pk_add_f32 v[114:115], v[114:115], s[62:63]
    v_pk_add_f32 v[116:117], v[116:117], s[62:63]
    v_pk_add_f32 v[118:119], v[118:119], s[62:63]
    v_med3_f32 v112, v64, v112, 1.0
    v_med3_f32 v113, v65, v113, 1.0
    v_med3_f32 v114, v66, v114, 1.0
    v_med3_f32 v115, v67, v115, 1.0
    v_med3_f32 v116, v68, v116, 1.0
    v_med3_f32 v117, v69, v117, 1.0
    v_med3_f32 v118, v70, v118, 1.0
    v_med3_f32 v119, v71, v119, 1.0
    v_pk_add_f32 v[112:113], v[112:113], s[64:65]
    v_pk_add_f32 v[114:115], v[114:115], s[64:65]
    v_pk_add_f32 v[116:117], v[116:117], s[64:65]
    v_pk_add_f32 v[118:119], v[118:119], s[64:65]
    v_pk_mul_f32 v[64:65], v[120:121], s[60:61]
    v_pk_mul_f32 v[66:67], v[122:123], s[60:61]
    v_pk_mul_f32 v[68:69], v[124:125], s[60:61]
    v_pk_mul_f32 v[70:71], v[126:127], s[60:61]
    v_exp_f32 v64, v64
    v_exp_f32 v65, v65
    v_exp_f32 v66, v66
    v_exp_f32 v67, v67
    v_exp_f32 v68, v68
    v_exp_f32 v69, v69
    v_exp_f32 v70, v70
    v_exp_f32 v71, v71
    v_pk_add_f32 v[120:121], v[120:121], s[62:63]
    v_pk_add_f32 v[122:123], v[122:123], s[62:63]
    v_pk_add_f32 v[124:125], v[124:125], s[62:63]
    v_pk_add_f32 v[126:127], v[126:127], s[62:63]
    v_med3_f32 v120, v64, v120, 1.0
    v_med3_f32 v121, v65, v121, 1.0
    v_med3_f32 v122, v66, v122, 1.0
    v_med3_f32 v123, v67, v123, 1.0
    v_med3_f32 v124, v68, v124, 1.0
    v_med3_f32 v125, v69, v125, 1.0
    v_med3_f32 v126, v70, v126, 1.0
    v_med3_f32 v127, v71, v127, 1.0
    v_pk_add_f32 v[120:121], v[120:121], s[64:65]
    v_pk_add_f32 v[122:123], v[122:123], s[64:65]
    v_pk_add_f32 v[124:125], v[124:125], s[64:65]
    v_pk_add_f32 v[126:127], v[126:127], s[64:65]
    v_pk_mul_f32 v[64:65], v[128:129], s[60:61]
    v_pk_mul_f32 v[66:67], v[130:131], s[60:61]
    v_pk_mul_f32 v[68:69], v[132:133], s[60:61]
    v_pk_mul_f32 v[70:71], v[134:135], s[60:61]
    v_exp_f32 v64, v64
    v_exp_f32 v65, v65
    v_exp_f32 v66, v66
    v_exp_f32 v67, v67
    v_exp_f32 v68, v68
    v_exp_f32 v69, v69
    v_exp_f32 v70, v70
    v_exp_f32 v71, v71
    v_pk_add_f32 v[128:129], v[128:129], s[62:63]
    v_pk_add_f32 v[130:131], v[130:131], s[62:63]
    v_pk_add_f32 v[132:133], v[132:133], s[62:63]
    v_pk_add_f32 v[134:135], v[134:135], s[62:63]
    v_med3_f32 v128, v64, v128, 1.0
    v_med3_f32 v129, v65, v129, 1.0
    v_med3_f32 v130, v66, v130, 1.0
    v_med3_f32 v131, v67, v131, 1.0
    v_med3_f32 v132, v68, v132, 1.0
    v_med3_f32 v133, v69, v133, 1.0
    v_med3_f32 v134, v70, v134, 1.0
    v_med3_f32 v135, v71, v135, 1.0
    v_pk_add_f32 v[128:129], v[128:129], s[64:65]
    v_pk_add_f32 v[130:131], v[130:131], s[64:65]
    v_pk_add_f32 v[132:133], v[132:133], s[64:65]
    v_pk_add_f32 v[134:135], v[134:135], s[64:65]
    v_pk_mul_f32 v[64:65], v[136:137], s[60:61]
    v_pk_mul_f32 v[66:67], v[138:139], s[60:61]
    v_pk_mul_f32 v[68:69], v[140:141], s[60:61]
    v_pk_mul_f32 v[70:71], v[142:143], s[60:61]
    v_exp_f32 v64, v64
    v_exp_f32 v65, v65
    v_exp_f32 v66, v66
    v_exp_f32 v67, v67
    v_exp_f32 v68, v68
    v_exp_f32 v69, v69
    v_exp_f32 v70, v70
    v_exp_f32 v71, v71
    v_pk_add_f32 v[136:137], v[136:137], s[62:63]
    v_pk_add_f32 v[138:139], v[138:139], s[62:63]
    v_pk_add_f32 v[140:141], v[140:141], s[62:63]
    v_pk_add_f32 v[142:143], v[142:143], s[62:63]
    v_med3_f32 v136, v64, v136, 1.0
    v_med3_f32 v137, v65, v137, 1.0
    v_med3_f32 v138, v66, v138, 1.0
    v_med3_f32 v139, v67, v139, 1.0
    v_med3_f32 v140, v68, v140, 1.0
    v_med3_f32 v141, v69, v141, 1.0
    v_med3_f32 v142, v70, v142, 1.0
    v_med3_f32 v143, v71, v143, 1.0
    v_pk_add_f32 v[136:137], v[136:137], s[64:65]
    v_pk_add_f32 v[138:139], v[138:139], s[64:65]
    v_pk_add_f32 v[140:141], v[140:141], s[64:65]
    v_pk_add_f32 v[142:143], v[142:143], s[64:65]
    s_waitcnt lgkmcnt(0)
    s_barrier
    s_lshl_b32 s40, s31, 11
    s_add_u32 s40, s40, 65536
    v_add_u32 v7, s40, v246
    v_cvt_pk_bf16_f32 v80, v112, v113
    v_cvt_pk_bf16_f32 v81, v114, v115
    v_cvt_pk_bf16_f32 v82, v116, v117
    v_cvt_pk_bf16_f32 v83, v118, v119
    ds_write_b128 v7, v[80:83] offset:12288
    v_cvt_pk_bf16_f32 v84, v120, v121
    v_cvt_pk_bf16_f32 v85, v122, v123
    v_cvt_pk_bf16_f32 v86, v124, v125
    v_cvt_pk_bf16_f32 v87, v126, v127
    ds_write_b128 v7, v[84:87] offset:13312
    v_cvt_pk_bf16_f32 v88, v128, v129
    v_cvt_pk_bf16_f32 v89, v130, v131
    v_cvt_pk_bf16_f32 v90, v132, v133
    v_cvt_pk_bf16_f32 v91, v134, v135
    ds_write_b128 v7, v[88:91] offset:16384
    v_cvt_pk_bf16_f32 v92, v136, v137
    v_cvt_pk_bf16_f32 v93, v138, v139
    v_cvt_pk_bf16_f32 v94, v140, v141
    v_cvt_pk_bf16_f32 v95, v142, v143
    ds_write_b128 v7, v[92:95] offset:17408
    v_cvt_pk_bf16_f32 v80, v144, v145
    v_cvt_pk_bf16_f32 v81, v146, v147
    v_cvt_pk_bf16_f32 v82, v148, v149
    v_cvt_pk_bf16_f32 v83, v150, v151
    ds_write_b128 v7, v[80:83] offset:20480
    v_cvt_pk_bf16_f32 v84, v152, v153
    v_cvt_pk_bf16_f32 v85, v154, v155
    v_cvt_pk_bf16_f32 v86, v156, v157
    v_cvt_pk_bf16_f32 v87, v158, v159
    ds_write_b128 v7, v[84:87] offset:21504
    v_cvt_pk_bf16_f32 v88, v160, v161
    v_cvt_pk_bf16_f32 v89, v162, v163
    v_cvt_pk_bf16_f32 v90, v164, v165
    v_cvt_pk_bf16_f32 v91, v166, v167
    ds_write_b128 v7, v[88:91] offset:24576
    v_cvt_pk_bf16_f32 v92, v168, v169
    v_cvt_pk_bf16_f32 v93, v170, v171
    v_cvt_pk_bf16_f32 v94, v172, v173
    v_cvt_pk_bf16_f32 v95, v174, v175
    ds_write_b128 v7, v[92:95] offset:25600
    v_cvt_pk_bf16_f32 v80, v176, v177
    v_cvt_pk_bf16_f32 v81, v178, v179
    v_cvt_pk_bf16_f32 v82, v180, v181
    v_cvt_pk_bf16_f32 v83, v182, v183
    ds_write_b128 v7, v[80:83] offset:28672
    v_cvt_pk_bf16_f32 v84, v184, v185
    v_cvt_pk_bf16_f32 v85, v186, v187
    v_cvt_pk_bf16_f32 v86, v188, v189
    v_cvt_pk_bf16_f32 v87, v190, v191
    ds_write_b128 v7, v[84:87] offset:29696
    v_cvt_pk_bf16_f32 v88, v192, v193
    v_cvt_pk_bf16_f32 v89, v194, v195
    v_cvt_pk_bf16_f32 v90, v196, v197
    v_cvt_pk_bf16_f32 v91, v198, v199
    ds_write_b128 v7, v[88:91] offset:32768
    v_cvt_pk_bf16_f32 v92, v200, v201
    v_cvt_pk_bf16_f32 v93, v202, v203
    v_cvt_pk_bf16_f32 v94, v204, v205
    v_cvt_pk_bf16_f32 v95, v206, v207
    ds_write_b128 v7, v[92:95] offset:33792
    v_cvt_pk_bf16_f32 v80, v208, v209
    v_cvt_pk_bf16_f32 v81, v210, v211
    v_cvt_pk_bf16_f32 v82, v212, v213
    v_cvt_pk_bf16_f32 v83, v214, v215
    ds_write_b128 v7, v[80:83] offset:36864
    v_cvt_pk_bf16_f32 v84, v216, v217
    v_cvt_pk_bf16_f32 v85, v218, v219
    v_cvt_pk_bf16_f32 v86, v220, v221
    v_cvt_pk_bf16_f32 v87, v222, v223
    ds_write_b128 v7, v[84:87] offset:37888
    s_branch P1_STORE
P1_V0_A_SPIN:
    ds_read_b128 v[240:243], v244
    s_waitcnt lgkmcnt(0)
    v_min3_u32 v1, v240, v241, v242
    v_min_u32 v1, v1, v243
    s_nop 0
    v_readfirstlane_b32 s40, v1
    s_add_u32 s98, s98, 1
    s_cmp_gt_u32 s98, 524288
    s_cbranch_scc1 P1_V0_A_GO
    s_cmp_lt_u32 s40, s35
    s_cbranch_scc1 P1_V0_A_SPIN
    s_branch P1_V0_A_GO
P1_V0_B_SPIN:
    ds_read_b128 v[240:243], v244
    s_waitcnt lgkmcnt(0)
    v_min3_u32 v1, v240, v241, v242
    v_min_u32 v1, v1, v243
    s_nop 0
    v_readfirstlane_b32 s40, v1
    s_add_u32 s98, s98, 1
    s_cmp_gt_u32 s98, 524288
    s_cbranch_scc1 P1_V0_B_GO
    s_cmp_lt_u32 s40, s35
    s_cbranch_scc1 P1_V0_B_SPIN
    s_branch P1_V0_B_GO
P1_V1_A_SPIN:
    ds_read_b128 v[240:243], v244
    s_waitcnt lgkmcnt(0)
    v_min3_u32 v1, v240, v241, v242
    v_min_u32 v1, v1, v243
    s_nop 0
    v_readfirstlane_b32 s40, v1
    s_add_u32 s98, s98, 1
    s_cmp_gt_u32 s98, 524288
    s_cbranch_scc1 P1_V1_A_GO
    s_cmp_lt_u32 s40, s35
    s_cbranch_scc1 P1_V1_A_SPIN
    s_branch P1_V1_A_GO
P1_V1_B_SPIN:
    ds_read_b128 v[240:243], v244
    s_waitcnt lgkmcnt(0)
    v_min3_u32 v1, v240, v241, v242
    v_min_u32 v1, v1, v243
    s_nop 0
    v_readfirstlane_b32 s40, v1
    s_add_u32 s98, s98, 1
    s_cmp_gt_u32 s98, 524288
    s_cbranch_scc1 P1_V1_B_GO
    s_cmp_lt_u32 s40, s35
    s_cbranch_scc1 P1_V1_B_SPIN
    s_branch P1_V1_B_GO
P1_V2_A_SPIN:
    ds_read_b128 v[240:243], v244
    s_waitcnt lgkmcnt(0)
    v_min3_u32 v1, v240, v241, v242
    v_min_u32 v1, v1, v243
    s_nop 0
    v_readfirstlane_b32 s40, v1
    s_add_u32 s98, s98, 1
    s_cmp_gt_u32 s98, 524288
    s_cbranch_scc1 P1_V2_A_GO
    s_cmp_lt_u32 s40, s35
    s_cbranch_scc1 P1_V2_A_SPIN
    s_branch P1_V2_A_GO
P1_V2_B_SPIN:
    ds_read_b128 v[240:243], v244
    s_waitcnt lgkmcnt(0)
    v_min3_u32 v1, v240, v241, v242
    v_min_u32 v1, v1, v243
    s_nop 0
    v_readfirstlane_b32 s40, v1
    s_add_u32 s98, s98, 1
    s_cmp_gt_u32 s98, 524288
    s_cbranch_scc1 P1_V2_B_GO
    s_cmp_lt_u32 s40, s35
    s_cbranch_scc1 P1_V2_B_SPIN
    s_branch P1_V2_B_GO
P1_V3_A_SPIN:
    ds_read_b128 v[240:243], v244
    s_waitcnt lgkmcnt(0)
    v_min3_u32 v1, v240, v241, v242
    v_min_u32 v1, v1, v243
    s_nop 0
    v_readfirstlane_b32 s40, v1
    s_add_u32 s98, s98, 1
    s_cmp_gt_u32 s98, 524288
    s_cbranch_scc1 P1_V3_A_GO
    s_cmp_lt_u32 s40, s35
    s_cbranch_scc1 P1_V3_A_SPIN
    s_branch P1_V3_A_GO
P1_V3_B_SPIN:
    ds_read_b128 v[240:243], v244
    s_waitcnt lgkmcnt(0)
    v_min3_u32 v1, v240, v241, v242
    v_min_u32 v1, v1, v243
    s_nop 0
    v_readfirstlane_b32 s40, v1
    s_add_u32 s98, s98, 1
    s_cmp_gt_u32 s98, 524288
    s_cbranch_scc1 P1_V3_B_GO
    s_cmp_lt_u32 s40, s35
    s_cbranch_scc1 P1_V3_B_SPIN
    s_branch P1_V3_B_GO
P1_STORE:
    v_lshlrev_b32 v1, 4, v2
    s_waitcnt lgkmcnt(0)
    s_barrier
    s_cmp_eq_u32 s29, 1
    s_cbranch_scc1 P1_ST_B
    s_lshl_b32 s40, s30, 13
    s_lshl_b32 s41, s28, 7
    s_add_u32 s40, s40, s41
    s_mul_i32 s40, s40, 40
    s_add_u32 s41, s24, 0
    s_lshl_b32 s42, s41, 10
    v_add_u32 v3, s42, v1
    ds_read_b128 v[16:19], v3 offset:20480
    s_mul_i32 s43, s41, 52429
    s_lshr_b32 s43, s43, 18
    s_mul_i32 s43, s43, 76800
    s_add_u32 s43, s43, s42
    s_add_u32 s43, s43, s40
    s_add_u32 s44, s43, 2621440
    s_waitcnt lgkmcnt(0)
    buffer_store_dwordx4 v[16:19], v1, s[36:39], s44 offen sc1
    s_add_u32 s41, s24, 8
    s_lshl_b32 s42, s41, 10
    v_add_u32 v3, s42, v1
    ds_read_b128 v[20:23], v3 offset:20480
    s_mul_i32 s43, s41, 52429
    s_lshr_b32 s43, s43, 18
    s_mul_i32 s43, s43, 76800
    s_add_u32 s43, s43, s42
    s_add_u32 s43, s43, s40
    s_add_u32 s45, s43, 2621440
    s_waitcnt lgkmcnt(0)
    buffer_store_dwordx4 v[20:23], v1, s[36:39], s45 offen sc1
    s_cmp_ge_u32 s24, 4
    s_cbranch_scc1 P1_SK
    s_add_u32 s41, s24, 16
    s_lshl_b32 s42, s41, 10
    v_add_u32 v3, s42, v1
    ds_read_b128 v[24:27], v3 offset:20480
    s_mul_i32 s43, s41, 52429
    s_lshr_b32 s43, s43, 18
    s_mul_i32 s43, s43, 76800
    s_add_u32 s43, s43, s42
    s_add_u32 s43, s43, s40
    s_add_u32 s46, s43, 2621440
    s_waitcnt lgkmcnt(0)
    buffer_store_dwordx4 v[24:27], v1, s[36:39], s46 offen sc1
P1_SK:
    s_add_u32 s48, s24, 4
    s_and_b32 s48, s48, 7
    s_add_u32 s41, s48, 10
    s_lshl_b32 s42, s41, 10
    v_add_u32 v3, s42, v1
    ds_read_b128 v[28:31], v3 offset:0
    s_mul_i32 s43, s41, 52429
    s_lshr_b32 s43, s43, 18
    s_mul_i32 s43, s43, 76800
    s_add_u32 s43, s43, s42
    s_add_u32 s43, s43, s40
    s_add_u32 s49, s43, 0
    s_waitcnt lgkmcnt(0)
    buffer_store_dwordx4 v[28:31], v1, s[36:39], s49 offen sc1
    s_cmp_ge_u32 s48, 2
    s_cbranch_scc1 P1_SQ23
    s_add_u32 s41, s48, 18
    s_lshl_b32 s42, s41, 10
    v_add_u32 v3, s42, v1
    ds_read_b128 v[32:35], v3 offset:0
    s_mul_i32 s43, s41, 52429
    s_lshr_b32 s43, s43, 18
    s_mul_i32 s43, s43, 76800
    s_add_u32 s43, s43, s42
    s_add_u32 s43, s43, s40
    s_add_u32 s50, s43, 0
    s_waitcnt lgkmcnt(0)
    buffer_store_dwordx4 v[32:35], v1, s[36:39], s50 offen sc1
P1_SQ23:
    s_branch P1_DONE
P1_ST_B:
    s_cmp_lt_u32 s24, 4
    s_cbranch_scc1 P1_KV
    s_sub_u32 s41, s24, 4
    s_mul_i32 s42, s41, 5120
    v_add_u32 v3, s42, v1
    ds_read_b128 v[16:19], v3 offset:0
    ds_read_b128 v[20:23], v3 offset:1024
    ds_read_b128 v[24:27], v3 offset:2048
    ds_read_b128 v[28:31], v3 offset:3072
    ds_read_b128 v[32:35], v3 offset:4096
    s_lshl_b32 s40, s30, 2
    s_add_u32 s40, s40, s41
    s_lshl_b32 s40, s40, 11
    s_lshl_b32 s41, s28, 7
    s_add_u32 s40, s40, s41
    s_mul_i32 s40, s40, 40
    s_add_u32 s40, s40, 7864320
    s_add_u32 s41, s40, 4096
    s_mov_b32 s60, 0x3fb8aa3b
    s_mov_b32 s61, 0x3fb8aa3b
    s_mov_b32 s62, 1.0
    s_mov_b32 s63, 1.0
    s_mov_b32 s64, 0x358637bd
    s_mov_b32 s65, 0x358637bd
    s_waitcnt lgkmcnt(0)
    v_lshlrev_b32 v40, 16, v16
    v_and_b32 v41, 0xffff0000, v16
    v_lshlrev_b32 v42, 16, v17
    v_and_b32 v43, 0xffff0000, v17
    v_lshlrev_b32 v44, 16, v18
    v_and_b32 v45, 0xffff0000, v18
    v_lshlrev_b32 v46, 16, v19
    v_and_b32 v47, 0xffff0000, v19
    v_pk_mul_f32 v[48:49], v[40:41], s[60:61]
    v_pk_mul_f32 v[50:51], v[42:43], s[60:61]
    v_pk_mul_f32 v[52:53], v[44:45], s[60:61]
    v_pk_mul_f32 v[54:55], v[46:47], s[60:61]
    v_exp_f32 v48, v48
    v_exp_f32 v49, v49
    v_exp_f32 v50, v50
    v_exp_f32 v51, v51
    v_exp_f32 v52, v52
    v_exp_f32 v53, v53
    v_exp_f32 v54, v54
    v_exp_f32 v55, v55
    v_pk_add_f32 v[40:41], v[40:41], s[62:63]
    v_pk_add_f32 v[42:43], v[42:43], s[62:63]
    v_pk_add_f32 v[44:45], v[44:45], s[62:63]
    v_pk_add_f32 v[46:47], v[46:47], s[62:63]
    v_med3_f32 v40, v48, v40, 1.0
    v_med3_f32 v41, v49, v41, 1.0
    v_med3_f32 v42, v50, v42, 1.0
    v_med3_f32 v43, v51, v43, 1.0
    v_med3_f32 v44, v52, v44, 1.0
    v_med3_f32 v45, v53, v45, 1.0
    v_med3_f32 v46, v54, v46, 1.0
    v_med3_f32 v47, v55, v47, 1.0
    v_pk_add_f32 v[40:41], v[40:41], s[64:65]
    v_pk_add_f32 v[42:43], v[42:43], s[64:65]
    v_pk_add_f32 v[44:45], v[44:45], s[64:65]
    v_pk_add_f32 v[46:47], v[46:47], s[64:65]
    v_cvt_pk_bf16_f32 v16, v40, v41
    v_cvt_pk_bf16_f32 v17, v42, v43
    v_cvt_pk_bf16_f32 v18, v44, v45
    v_cvt_pk_bf16_f32 v19, v46, v47
    buffer_store_dwordx4 v[16:19], v1, s[36:39], s40 offen offset:0 sc1
    v_lshlrev_b32 v40, 16, v20
    v_and_b32 v41, 0xffff0000, v20
    v_lshlrev_b32 v42, 16, v21
    v_and_b32 v43, 0xffff0000, v21
    v_lshlrev_b32 v44, 16, v22
    v_and_b32 v45, 0xffff0000, v22
    v_lshlrev_b32 v46, 16, v23
    v_and_b32 v47, 0xffff0000, v23
    v_pk_mul_f32 v[48:49], v[40:41], s[60:61]
    v_pk_mul_f32 v[50:51], v[42:43], s[60:61]
    v_pk_mul_f32 v[52:53], v[44:45], s[60:61]
    v_pk_mul_f32 v[54:55], v[46:47], s[60:61]
    v_exp_f32 v48, v48
    v_exp_f32 v49, v49
    v_exp_f32 v50, v50
    v_exp_f32 v51, v51
    v_exp_f32 v52, v52
    v_exp_f32 v53, v53
    v_exp_f32 v54, v54
    v_exp_f32 v55, v55
    v_pk_add_f32 v[40:41], v[40:41], s[62:63]
    v_pk_add_f32 v[42:43], v[42:43], s[62:63]
    v_pk_add_f32 v[44:45], v[44:45], s[62:63]
    v_pk_add_f32 v[46:47], v[46:47], s[62:63]
    v_med3_f32 v40, v48, v40, 1.0
    v_med3_f32 v41, v49, v41, 1.0
    v_med3_f32 v42, v50, v42, 1.0
    v_med3_f32 v43, v51, v43, 1.0
    v_med3_f32 v44, v52, v44, 1.0
    v_med3_f32 v45, v53, v45, 1.0
    v_med3_f32 v46, v54, v46, 1.0
    v_med3_f32 v47, v55, v47, 1.0
    v_pk_add_f32 v[40:41], v[40:41], s[64:65]
    v_pk_add_f32 v[42:43], v[42:43], s[64:65]
    v_pk_add_f32 v[44:45], v[44:45], s[64:65]
    v_pk_add_f32 v[46:47], v[46:47], s[64:65]
    v_cvt_pk_bf16_f32 v20, v40, v41
    v_cvt_pk_bf16_f32 v21, v42, v43
    v_cvt_pk_bf16_f32 v22, v44, v45
    v_cvt_pk_bf16_f32 v23, v46, v47
    buffer_store_dwordx4 v[20:23], v1, s[36:39], s40 offen offset:1024 sc1
    v_lshlrev_b32 v40, 16, v24
    v_and_b32 v41, 0xffff0000, v24
    v_lshlrev_b32 v42, 16, v25
    v_and_b32 v43, 0xffff0000, v25
    v_lshlrev_b32 v44, 16, v26
    v_and_b32 v45, 0xffff0000, v26
    v_lshlrev_b32 v46, 16, v27
    v_and_b32 v47, 0xffff0000, v27
    v_pk_mul_f32 v[48:49], v[40:41], s[60:61]
    v_pk_mul_f32 v[50:51], v[42:43], s[60:61]
    v_pk_mul_f32 v[52:53], v[44:45], s[60:61]
    v_pk_mul_f32 v[54:55], v[46:47], s[60:61]
    v_exp_f32 v48, v48
    v_exp_f32 v49, v49
    v_exp_f32 v50, v50
    v_exp_f32 v51, v51
    v_exp_f32 v52, v52
    v_exp_f32 v53, v53
    v_exp_f32 v54, v54
    v_exp_f32 v55, v55
    v_pk_add_f32 v[40:41], v[40:41], s[62:63]
    v_pk_add_f32 v[42:43], v[42:43], s[62:63]
    v_pk_add_f32 v[44:45], v[44:45], s[62:63]
    v_pk_add_f32 v[46:47], v[46:47], s[62:63]
    v_med3_f32 v40, v48, v40, 1.0
    v_med3_f32 v41, v49, v41, 1.0
    v_med3_f32 v42, v50, v42, 1.0
    v_med3_f32 v43, v51, v43, 1.0
    v_med3_f32 v44, v52, v44, 1.0
    v_med3_f32 v45, v53, v45, 1.0
    v_med3_f32 v46, v54, v46, 1.0
    v_med3_f32 v47, v55, v47, 1.0
    v_pk_add_f32 v[40:41], v[40:41], s[64:65]
    v_pk_add_f32 v[42:43], v[42:43], s[64:65]
    v_pk_add_f32 v[44:45], v[44:45], s[64:65]
    v_pk_add_f32 v[46:47], v[46:47], s[64:65]
    v_cvt_pk_bf16_f32 v24, v40, v41
    v_cvt_pk_bf16_f32 v25, v42, v43
    v_cvt_pk_bf16_f32 v26, v44, v45
    v_cvt_pk_bf16_f32 v27, v46, v47
    buffer_store_dwordx4 v[24:27], v1, s[36:39], s40 offen offset:2048 sc1
    v_lshlrev_b32 v40, 16, v28
    v_and_b32 v41, 0xffff0000, v28
    v_lshlrev_b32 v42, 16, v29
    v_and_b32 v43, 0xffff0000, v29
    v_lshlrev_b32 v44, 16, v30
    v_and_b32 v45, 0xffff0000, v30
    v_lshlrev_b32 v46, 16, v31
    v_and_b32 v47, 0xffff0000, v31
    v_pk_mul_f32 v[48:49], v[40:41], s[60:61]
    v_pk_mul_f32 v[50:51], v[42:43], s[60:61]
    v_pk_mul_f32 v[52:53], v[44:45], s[60:61]
    v_pk_mul_f32 v[54:55], v[46:47], s[60:61]
    v_exp_f32 v48, v48
    v_exp_f32 v49, v49
    v_exp_f32 v50, v50
    v_exp_f32 v51, v51
    v_exp_f32 v52, v52
    v_exp_f32 v53, v53
    v_exp_f32 v54, v54
    v_exp_f32 v55, v55
    v_pk_add_f32 v[40:41], v[40:41], s[62:63]
    v_pk_add_f32 v[42:43], v[42:43], s[62:63]
    v_pk_add_f32 v[44:45], v[44:45], s[62:63]
    v_pk_add_f32 v[46:47], v[46:47], s[62:63]
    v_med3_f32 v40, v48, v40, 1.0
    v_med3_f32 v41, v49, v41, 1.0
    v_med3_f32 v42, v50, v42, 1.0
    v_med3_f32 v43, v51, v43, 1.0
    v_med3_f32 v44, v52, v44, 1.0
    v_med3_f32 v45, v53, v45, 1.0
    v_med3_f32 v46, v54, v46, 1.0
    v_med3_f32 v47, v55, v47, 1.0
    v_pk_add_f32 v[40:41], v[40:41], s[64:65]
    v_pk_add_f32 v[42:43], v[42:43], s[64:65]
    v_pk_add_f32 v[44:45], v[44:45], s[64:65]
    v_pk_add_f32 v[46:47], v[46:47], s[64:65]
    v_cvt_pk_bf16_f32 v28, v40, v41
    v_cvt_pk_bf16_f32 v29, v42, v43
    v_cvt_pk_bf16_f32 v30, v44, v45
    v_cvt_pk_bf16_f32 v31, v46, v47
    buffer_store_dwordx4 v[28:31], v1, s[36:39], s40 offen offset:3072 sc1
    v_lshlrev_b32 v40, 16, v32
    v_and_b32 v41, 0xffff0000, v32
    v_lshlrev_b32 v42, 16, v33
    v_and_b32 v43, 0xffff0000, v33
    v_lshlrev_b32 v44, 16, v34
    v_and_b32 v45, 0xffff0000, v34
    v_lshlrev_b32 v46, 16, v35
    v_and_b32 v47, 0xffff0000, v35
    v_pk_mul_f32 v[48:49], v[40:41], s[60:61]
    v_pk_mul_f32 v[50:51], v[42:43], s[60:61]
    v_pk_mul_f32 v[52:53], v[44:45], s[60:61]
    v_pk_mul_f32 v[54:55], v[46:47], s[60:61]
    v_exp_f32 v48, v48
    v_exp_f32 v49, v49
    v_exp_f32 v50, v50
    v_exp_f32 v51, v51
    v_exp_f32 v52, v52
    v_exp_f32 v53, v53
    v_exp_f32 v54, v54
    v_exp_f32 v55, v55
    v_pk_add_f32 v[40:41], v[40:41], s[62:63]
    v_pk_add_f32 v[42:43], v[42:43], s[62:63]
    v_pk_add_f32 v[44:45], v[44:45], s[62:63]
    v_pk_add_f32 v[46:47], v[46:47], s[62:63]
    v_med3_f32 v40, v48, v40, 1.0
    v_med3_f32 v41, v49, v41, 1.0
    v_med3_f32 v42, v50, v42, 1.0
    v_med3_f32 v43, v51, v43, 1.0
    v_med3_f32 v44, v52, v44, 1.0
    v_med3_f32 v45, v53, v45, 1.0
    v_med3_f32 v46, v54, v46, 1.0
    v_med3_f32 v47, v55, v47, 1.0
    v_pk_add_f32 v[40:41], v[40:41], s[64:65]
    v_pk_add_f32 v[42:43], v[42:43], s[64:65]
    v_pk_add_f32 v[44:45], v[44:45], s[64:65]
    v_pk_add_f32 v[46:47], v[46:47], s[64:65]
    v_cvt_pk_bf16_f32 v32, v40, v41
    v_cvt_pk_bf16_f32 v33, v42, v43
    v_cvt_pk_bf16_f32 v34, v44, v45
    v_cvt_pk_bf16_f32 v35, v46, v47
    buffer_store_dwordx4 v[32:35], v1, s[36:39], s41 offen sc1
    s_branch P1_DONE
P1_KV:
    v_add_u32 v1, 65536, v1
    s_lshl_b32 s40, s24, 12
    v_add_u32 v7, s40, v1
    ds_read_b128 v[16:19], v7 offset:0
    ds_read_b128 v[32:35], v1 offset:16384
    ds_read_b128 v[48:51], v7 offset:20480
    ds_read_b128 v[64:67], v1 offset:36864
    ds_read_b128 v[20:23], v7 offset:1024
    ds_read_b128 v[36:39], v1 offset:17408
    ds_read_b128 v[52:55], v7 offset:21504
    ds_read_b128 v[68:71], v1 offset:37888
    ds_read_b128 v[24:27], v7 offset:2048
    ds_read_b128 v[40:43], v1 offset:18432
    ds_read_b128 v[56:59], v7 offset:22528
    ds_read_b128 v[72:75], v1 offset:38912
    ds_read_b128 v[28:31], v7 offset:3072
    ds_read_b128 v[44:47], v1 offset:19456
    ds_read_b128 v[60:63], v7 offset:23552
    ds_read_b128 v[76:79], v1 offset:39936
    v_mov_b32 v80, 0x3f803f80
    v_mov_b32 v81, 0x3f803f80
    v_mov_b32 v82, 0x3f803f80
    v_mov_b32 v83, 0x3f803f80
    s_mul_i32 s41, s24, 1792
    s_add_u32 s41, s41, 106496
    v_mul_u32_u24 v8, 80, v3
    v_add_u32 v8, s41, v8
    v_lshl_add_u32 v9, v4, 4, v8
    s_lshl_b32 s40, s24, 2
    v_subrev_u32 v10, s40, v3
    v_cmp_gt_u32 s[50:51], 4, v10
    v_cmp_eq_u32 s[52:53], s24, v4
    v_cmp_eq_u32 s[54:55], 0, v3
    v_mul_u32_u24 v10, 80, v10
    v_add_u32 v10, s41, v10
    v_lshl_add_u32 v11, v4, 4, v10
    s_and_b64 s[56:57], s[50:51], s[52:53]
    s_and_b64 s[58:59], s[54:55], s[52:53]
    s_waitcnt lgkmcnt(0)
    v_mfma_f32_16x16x32_bf16 v[112:115], v[16:19], v[48:51], 0
    v_mfma_f32_16x16x32_bf16 v[116:119], v[16:19], v[64:67], 0
    v_mfma_f32_16x16x32_bf16 v[120:123], v[32:35], v[48:51], 0
    v_mfma_f32_16x16x32_bf16 v[124:127], v[32:35], v[64:67], 0
    v_mfma_f32_16x16x32_bf16 v[128:131], v[16:19], v[80:83], 0
    v_mfma_f32_16x16x32_bf16 v[132:135], v[32:35], v[80:83], 0
    v_mfma_f32_16x16x32_bf16 v[112:115], v[20:23], v[52:55], v[112:115]
    v_mfma_f32_16x16x32_bf16 v[116:119], v[20:23], v[68:71], v[116:119]
    v_mfma_f32_16x16x32_bf16 v[120:123], v[36:39], v[52:55], v[120:123]
    v_mfma_f32_16x16x32_bf16 v[124:127], v[36:39], v[68:71], v[124:127]
    v_mfma_f32_16x16x32_bf16 v[128:131], v[20:23], v[80:83], v[128:131]
    v_mfma_f32_16x16x32_bf16 v[132:135], v[36:39], v[80:83], v[132:135]
    v_mfma_f32_16x16x32_bf16 v[112:115], v[24:27], v[56:59], v[112:115]
    v_mfma_f32_16x16x32_bf16 v[116:119], v[24:27], v[72:75], v[116:119]
    v_mfma_f32_16x16x32_bf16 v[120:123], v[40:43], v[56:59], v[120:123]
    v_mfma_f32_16x16x32_bf16 v[124:127], v[40:43], v[72:75], v[124:127]
    v_mfma_f32_16x16x32_bf16 v[128:131], v[24:27], v[80:83], v[128:131]
    v_mfma_f32_16x16x32_bf16 v[132:135], v[40:43], v[80:83], v[132:135]
    v_mfma_f32_16x16x32_bf16 v[112:115], v[28:31], v[60:63], v[112:115]
    v_mfma_f32_16x16x32_bf16 v[116:119], v[28:31], v[76:79], v[116:119]
    v_mfma_f32_16x16x32_bf16 v[120:123], v[44:47], v[60:63], v[120:123]
    v_mfma_f32_16x16x32_bf16 v[124:127], v[44:47], v[76:79], v[124:127]
    v_mfma_f32_16x16x32_bf16 v[128:131], v[28:31], v[80:83], v[128:131]
    v_mfma_f32_16x16x32_bf16 v[132:135], v[44:47], v[80:83], v[132:135]
    v_lshlrev_b32 v12, 2, v2
    v_add_u32 v13, s41, v12
    s_nop 0
    ds_write_b128 v9, v[112:115]
    s_mov_b64 exec, s[50:51]
    ds_write_b128 v11, v[116:119] offset:1280
    s_mov_b64 exec, s[52:53]
    ds_write_b128 v8, v[120:123] offset:64
    s_mov_b64 exec, s[56:57]
    ds_write_b128 v10, v[124:127] offset:1344
    s_mov_b64 exec, s[54:55]
    ds_write_b128 v9, v[128:131] offset:1600
    s_mov_b64 exec, s[58:59]
    ds_write_b128 v8, v[132:135] offset:1664
    s_mov_b64 exec, -1
    s_waitcnt lgkmcnt(0)
    ds_read_b32 v16, v13 offset:0
    ds_read_b32 v17, v13 offset:256
    ds_read_b32 v18, v13 offset:512
    ds_read_b32 v19, v13 offset:768
    ds_read_b32 v20, v13 offset:1024
    ds_read_b32 v21, v13 offset:1280
    ds_read_b32 v22, v13 offset:1536
    s_lshl_b32 s40, s30, 2
    s_add_u32 s40, s40, s24
    s_mul_i32 s40, s40, 1680
    s_add_u32 s40, s40, 17383424
    s_waitcnt lgkmcnt(0)
    buffer_atomic_add_f32 v16, v12, s[36:39], s40 offen offset:0
    buffer_atomic_add_f32 v17, v12, s[36:39], s40 offen offset:256
    buffer_atomic_add_f32 v18, v12, s[36:39], s40 offen offset:512
    buffer_atomic_add_f32 v19, v12, s[36:39], s40 offen offset:768
    buffer_atomic_add_f32 v20, v12, s[36:39], s40 offen offset:1024
    buffer_atomic_add_f32 v21, v12, s[36:39], s40 offen offset:1280
    s_mov_b32 exec_hi, 0xf
    buffer_atomic_add_f32 v22, v12, s[36:39], s40 offen offset:1536
    s_mov_b32 exec_hi, -1
P1_DONE:
    s_waitcnt vmcnt(0) lgkmcnt(0)
P1_DONE2:
    s_barrier
    s_cmp_lg_u32 s24, 0
    s_cbranch_scc1 P1_NOFLAG
    s_lshl_b32 s42, s27, 6
    s_lshl_b32 s41, s28, 2
    s_add_u32 s41, s42, s41
    s_add_u32 s41, s41, 17375232
    v_mov_b32 v56, 1
    v_mov_b32 v57, 0
    s_mov_b64 exec, 1
    buffer_store_dword v56, v57, s[36:39], s41 offen sc1
    s_mov_b64 exec, -1
P1_NOFLAG:
    s_cmp_eq_u32 s29, 1
    s_cbranch_scc1 P1_NOB2
    v_lshrrev_b32 v4, 4, v2
    v_and_b32 v5, 15, v2
    v_mul_u32_u24 v6, 272, v4
    v_lshl_add_u32 v6, v5, 4, v6
    v_lshlrev_b32 v7, 12, v4
    v_lshl_add_u32 v7, v5, 4, v7
    s_mul_i32 s47, s30, 327680
    s_lshl_b32 s41, s28, 8
    s_add_u32 s47, s47, s41
    s_add_u32 s47, s47, 5242880
    s_cmp_eq_u32 s24, 0
    s_cbranch_scc1 P1_SV
    s_sub_u32 s49, s24, 1
    s_add_u32 s41, s49, 0
    s_mul_i32 s42, s41, 1088
    v_add_u32 v3, s42, v6
    ds_read_b128 v[36:39], v3 offset:40960
    s_lshl_b32 s43, s41, 14
    s_add_u32 s44, s43, s47
    s_waitcnt lgkmcnt(0)
    buffer_store_dwordx4 v[36:39], v7, s[36:39], s44 offen sc1
    s_add_u32 s41, s49, 7
    s_mul_i32 s42, s41, 1088
    v_add_u32 v3, s42, v6
    ds_read_b128 v[40:43], v3 offset:40960
    s_lshl_b32 s43, s41, 14
    s_add_u32 s45, s43, s47
    s_waitcnt lgkmcnt(0)
    buffer_store_dwordx4 v[40:43], v7, s[36:39], s45 offen sc1
    s_cmp_ge_u32 s49, 6
    s_cbranch_scc1 P1_SV
    s_add_u32 s41, s49, 14
    s_mul_i32 s42, s41, 1088
    v_add_u32 v3, s42, v6
    ds_read_b128 v[44:47], v3 offset:40960
    s_lshl_b32 s43, s41, 14
    s_add_u32 s46, s43, s47
    s_waitcnt lgkmcnt(0)
    buffer_store_dwordx4 v[44:47], v7, s[36:39], s46 offen sc1
P1_SV:
P1_NOB2:
    s_lshl_b32 s25, s30, 1
    s_add_u32 s25, s25, s29
    s_lshr_b32 s31, s24, 2
    s_and_b32 s32, s24, 3
    s_lshl_b32 s33, s25, 1
    s_add_u32 s33, s33, s31
    s_mul_i32 s34, s31, 32768
    s_lshl_b32 s35, s28, 7
    s_sub_i32 s26, s35, 256
    v_and_b32 v3, 31, v2
    v_lshrrev_b32 v4, 5, v2
    v_lshlrev_b32 v5, 4, v2
    s_mul_i32 s60, s26, 40
    s_lshl_b32 s61, s32, 10
    s_add_i32 s60, s60, s61
    v_add_u32 v6, s60, v5
    v_max_i32 v10, 0, v6
    v_add_u32 v11, 4096, v6
    v_max_i32 v11, 0, v11
    v_add_u32 v12, 8192, v6
    v_max_i32 v12, 0, v12
    v_add_u32 v13, 12288, v6
    v_max_i32 v13, 0, v13
    s_mul_i32 s62, s33, 81920
    s_lshl_b32 s60, s26, 1
    v_add_u32 v14, s60, v5
    v_max_i32 v14, 0, v14
    s_lshl_b32 s63, s32, 5
    s_add_u32 s63, s63, s35
    s_mul_i32 s64, s63, 40
    s_add_u32 s64, s64, s62
    v_mul_u32_u24 v7, 40, v3
    v_lshl_add_u32 v8, v4, 4, v7
    s_add_u32 s40, s22, 2621440
    s_addc_u32 s41, s23, 0
    s_and_b32 s41, s41, 0xffff
    s_mov_b32 s42, 2621440
    s_mov_b32 s43, 0x00020000
    s_add_u32 s44, s22, 5242880
    s_addc_u32 s45, s23, 0
    s_and_b32 s45, s45, 0xffff
    s_mov_b32 s46, 2621440
    s_mov_b32 s47, 0x00020000
    s_add_u32 s48, s22, 0
    s_addc_u32 s49, s23, 0
    s_and_b32 s49, s49, 0xffff
    s_mov_b32 s50, 2621440
    s_mov_b32 s51, 0x00020000
    s_add_u32 s52, s22, 7864320
    s_addc_u32 s53, s23, 0
    s_and_b32 s53, s53, 0xffff
    s_mov_b32 s54, 2621440
    s_mov_b32 s55, 0x00020000
    s_add_u32 s56, s22, 17383424
    s_addc_u32 s57, s23, 0
    s_and_b32 s57, s57, 0xffff
    s_mov_b32 s58, 53760
    s_mov_b32 s59, 0x00020000
    s_cmp_lg_u32 s29, 0
    s_cbranch_scc1 P2_NOLQ
    s_mul_i32 s60, s24, 1280
    v_add_u32 v22, s60, v8
    v_add_u32 v23, s60, v7
    ds_read_b64 v[16:17], v22 offset:0
    ds_read_b64 v[18:19], v22 offset:8
    ds_read_b64 v[20:21], v23 offset:32
P2_NOLQ:
    s_cmp_eq_u32 s24, 0
    s_cbranch_scc1 P2_E4
    s_waitcnt vmcnt(0)
P2_E4:
    s_waitcnt lgkmcnt(0)
    s_barrier
    s_sub_i32 s60, s28, 2
    v_add_u32 v56, s60, v2
    v_max_i32 v56, 0, v56
    v_min_u32 v56, s28, v56
    v_lshlrev_b32 v15, 2, v56
    s_cmp_lg_u32 s24, 1
    s_cbranch_scc1 P2_NOFV
    s_cmp_lg_u32 s29, 0
    s_cbranch_scc1 P2_NOFV
    s_lshl_b32 s60, s30, 6
    s_lshl_b32 s61, s28, 2
    s_add_u32 s60, s60, s61
    s_add_u32 s60, s60, 17377280
    v_mov_b32 v56, 1
    v_mov_b32 v57, 0
    s_mov_b64 exec, 1
    buffer_store_dword v56, v57, s[36:39], s60 offen sc1
    s_mov_b64 exec, -1
P2_NOFV:
    s_cmp_lg_u32 s24, 0
    s_cbranch_scc1 P2_W1
    s_lshl_b32 s60, s30, 6
    s_add_u32 s60, s60, 17375232
    s_mov_b32 s98, 0
POLL2:
    buffer_load_dword v57, v15, s[36:39], s60 offen sc1
    s_waitcnt vmcnt(0)
    v_cmp_ne_u32 vcc, 1, v57
    s_nop 1
    s_cmp_eq_u64 vcc, 0
    s_cbranch_scc1 POLL2_OK
    s_sleep 1
    s_add_u32 s98, s98, 1
    s_cmp_lt_u32 s98, 65536
    s_cbranch_scc1 POLL2
POLL2_OK:
P2_W1:
    s_barrier
    s_lshl_b32 s60, s32, 10
    s_add_u32 s60, s60, s34
    s_add_u32 m0, s60, 0
    s_nop 0
    buffer_load_dwordx4 v10, s[40:43], s62 offen lds
    s_add_u32 m0, s60, 4096
    s_nop 0
    buffer_load_dwordx4 v11, s[40:43], s62 offen lds
    s_add_u32 m0, s60, 8192
    s_nop 0
    buffer_load_dwordx4 v12, s[40:43], s62 offen lds
    s_cmp_eq_u32 s32, 3
    s_cbranch_scc1 P2_SKIPK
    s_add_u32 m0, s60, 12288
    s_nop 0
    buffer_load_dwordx4 v13, s[40:43], s62 offen lds
P2_SKIPK:
    s_cmp_eq_u32 s29, 0
    s_cbranch_scc1 P2_NOGQ
    buffer_load_dwordx4 v[16:19], v8, s[48:51], s64 offen
    buffer_load_dwordx2 v[20:21], v7, s[48:51], s64 offen offset:32
P2_NOGQ:
    v_mov_b32 v78, v15
    s_lshl_b32 s60, s32, 9
    v_lshlrev_b32 v22, 3, v2
    v_add_u32 v22, s60, v22
    v_mov_b32 v64, 0x3f803f80
    v_mov_b32 v65, 0x3f803f80
    v_add_u32 v66, s34, v22
    v_cmp_gt_u32 vcc, 784, v22
    s_nop 1
    s_and_saveexec_b64 s[60:61], vcc
    ds_write_b64 v66, v[64:65] offset:31040
    ds_write_b64 v66, v[64:65] offset:31936
    s_mov_b64 exec, s[60:61]
    v_mov_b32 v56, 32720
    v_mov_b32 v58, 0
    v_mov_b32 v59, 0
    ds_write_b64 v56, v[58:59]
    ds_write_b64 v56, v[58:59] offset:8
    v_lshlrev_b32 v67, 2, v4
    v_sub_u32 v67, v3, v67
    v_cmp_gt_i32 s[66:67], 0, v67
    v_cmp_gt_i32 s[68:69], 1, v67
    v_cmp_gt_i32 s[70:71], 2, v67
    v_cmp_gt_i32 s[72:73], 3, v67
    v_cmp_gt_i32 s[74:75], 16, v67
    v_cmp_gt_i32 s[76:77], 17, v67
    v_cmp_gt_i32 s[78:79], 18, v67
    v_cmp_gt_i32 s[80:81], 19, v67
    v_cmp_gt_i32 s[82:83], 8, v67
    v_cmp_gt_i32 s[84:85], 9, v67
    v_cmp_gt_i32 s[86:87], 10, v67
    v_cmp_gt_i32 s[88:89], 11, v67
    v_cmp_gt_i32 s[90:91], 24, v67
    v_cmp_gt_i32 s[92:93], 25, v67
    v_cmp_gt_i32 s[94:95], 26, v67
    v_cmp_gt_i32 s[96:97], 27, v67
    v_mov_b32 v64, 0xffff
    v_mov_b32 v65, 0xffff0000
    v_cndmask_b32 v68, 0, v64, s[66:67]
    v_cndmask_b32 v76, 0, v65, s[68:69]
    v_or_b32 v68, v68, v76
    v_cndmask_b32 v69, 0, v64, s[70:71]
    v_cndmask_b32 v76, 0, v65, s[72:73]
    v_or_b32 v69, v69, v76
    v_cndmask_b32 v70, 0, v64, s[74:75]
    v_cndmask_b32 v76, 0, v65, s[76:77]
    v_or_b32 v70, v70, v76
    v_cndmask_b32 v71, 0, v64, s[78:79]
    v_cndmask_b32 v76, 0, v65, s[80:81]
    v_or_b32 v71, v71, v76
    v_cndmask_b32 v72, 0, v64, s[82:83]
    v_cndmask_b32 v76, 0, v65, s[84:85]
    v_or_b32 v72, v72, v76
    v_cndmask_b32 v73, 0, v64, s[86:87]
    v_cndmask_b32 v76, 0, v65, s[88:89]
    v_or_b32 v73, v73, v76
    v_cndmask_b32 v74, 0, v64, s[90:91]
    v_cndmask_b32 v76, 0, v65, s[92:93]
    v_or_b32 v74, v74, v76
    v_cndmask_b32 v75, 0, v64, s[94:95]
    v_cndmask_b32 v76, 0, v65, s[96:97]
    v_or_b32 v75, v75, v76
    v_and_b32 v64, 7, v3
    v_bfe_u32 v65, v3, 3, 1
    v_lshl_add_u32 v64, v65, 4, v64
    v_bfe_u32 v65, v3, 4, 1
    v_lshl_add_u32 v64, v65, 3, v64
    v_mul_u32_u24 v64, 40, v64
    s_mul_i32 s60, s32, 1280
    s_add_u32 s60, s60, s34
    v_add_u32 v64, s60, v64
    v_lshl_add_u32 v65, v4, 4, v64
    v_mul_u32_u24 v66, 784, v3
    v_add_u32 v66, 15360, v66
    v_cmp_lt_u32 vcc, 19, v3
    v_mov_b32 v76, 31040
    v_mov_b32 v77, 31936
    v_cndmask_b32 v66, v66, v76, vcc
    v_cmp_lt_u32 vcc, 27, v3
    s_lshl_b32 s60, s32, 6
    s_add_u32 s60, s60, s34
    v_cndmask_b32 v66, v66, v77, vcc
    v_lshl_add_u32 v66, v4, 4, v66
    v_add_u32 v66, s60, v66
    v_and_b32 v77, 15, v2
    v_lshrrev_b32 v15, 4, v2
    v_mul_u32_u24 v9, 40, v77
    v_lshl_add_u32 v9, v15, 4, v9
    v_mul_u32_u24 v10, 80, v77
    v_lshl_add_u32 v10, v15, 5, v10
    v_lshlrev_b32 v11, 5, v15
    v_add_u32 v11, 1600, v11
    v_mov_b32 v76, 0x7fffffff
    v_cmp_gt_u32 vcc, 3, v15
    v_cmp_gt_u32 s[60:61], 2, v15
    s_nop 0
    v_cndmask_b32 v12, v76, v10, vcc
    v_cndmask_b32 v13, v76, v10, s[60:61]
    v_cndmask_b32 v10, v76, v11, vcc
    v_cndmask_b32 v11, v76, v11, s[60:61]
    v_mov_b32 v30, 0
    v_mov_b32 v31, 0
    v_mov_b32 v38, 0
    v_mov_b32 v39, 0
    v_mov_b32 v46, 0
    v_mov_b32 v47, 0
    v_mov_b32 v54, 0
    v_mov_b32 v55, 0
    s_mul_i32 s65, s33, 1680
    s_cmp_lg_u32 s24, 0
    s_cbranch_scc1 P2_W2
    s_lshl_b32 s60, s30, 6
    s_add_u32 s60, s60, 17377280
    s_mov_b32 s98, 0
POLL3:
    buffer_load_dword v56, v78, s[36:39], s60 offen sc1
    s_waitcnt vmcnt(0)
    v_cmp_ne_u32 vcc, 1, v56
    s_nop 1
    s_cmp_eq_u64 vcc, 0
    s_cbranch_scc1 POLL3_OK
    s_sleep 1
    s_add_u32 s98, s98, 1
    s_cmp_lt_u32 s98, 65536
    s_cbranch_scc1 POLL3
POLL3_OK:
P2_W2:
    s_waitcnt vmcnt(0) lgkmcnt(0)
    s_barrier
    s_cmp_lt_u32 s24, 4
    s_cbranch_scc1 P2_OLD
    s_mul_i32 s60, s25, 40
    s_mul_i32 s61, s32, 5
    s_add_u32 s60, s60, s61
    s_lshl_b32 s60, s60, 12
    s_mul_i32 s61, s32, 3920
    s_add_u32 s61, s61, 15360
    s_mov_b32 exec_hi, 0xffff
    s_add_u32 m0, s61, 0
    s_nop 0
    buffer_load_dwordx4 v14, s[44:47], s60 offen lds
    s_add_u32 s60, s60, 4096
    s_add_u32 m0, s61, 784
    s_nop 0
    buffer_load_dwordx4 v14, s[44:47], s60 offen lds
    s_add_u32 s60, s60, 4096
    s_add_u32 m0, s61, 1568
    s_nop 0
    buffer_load_dwordx4 v14, s[44:47], s60 offen lds
    s_add_u32 s60, s60, 4096
    s_add_u32 m0, s61, 2352
    s_nop 0
    buffer_load_dwordx4 v14, s[44:47], s60 offen lds
    s_add_u32 s60, s60, 4096
    s_add_u32 m0, s61, 3136
    s_nop 0
    buffer_load_dwordx4 v14, s[44:47], s60 offen lds
    s_add_u32 s60, s60, 65536
    s_add_u32 m0, s61, 32768
    s_nop 0
    buffer_load_dwordx4 v14, s[44:47], s60 offen lds
    s_add_u32 s60, s60, 4096
    s_add_u32 m0, s61, 33552
    s_nop 0
    buffer_load_dwordx4 v14, s[44:47], s60 offen lds
    s_add_u32 s60, s60, 4096
    s_add_u32 m0, s61, 34336
    s_nop 0
    buffer_load_dwordx4 v14, s[44:47], s60 offen lds
    s_add_u32 s60, s60, 4096
    s_add_u32 m0, s61, 35120
    s_nop 0
    buffer_load_dwordx4 v14, s[44:47], s60 offen lds
    s_add_u32 s60, s60, 4096
    s_add_u32 m0, s61, 35904
    s_nop 0
    buffer_load_dwordx4 v14, s[44:47], s60 offen lds
    s_add_u32 s60, s60, 65536
    s_mov_b32 exec_hi, -1
    s_lshl_b32 s60, s32, 2
    s_add_u32 s60, s60, 32720
    v_mov_b32 v56, s60
    v_mov_b32 v57, 1
    s_waitcnt vmcnt(0)
    ds_write_b32 v56, v57
    s_branch P2_QK
P2_OLD:
    s_setprio 2
P2_QK:
    v_cmp_eq_u32 vcc, 0, v4
    v_mov_b32 v22, 0
    v_mov_b32 v23, 0
    v_cndmask_b32 v20, 0, v20, vcc
    v_cndmask_b32 v21, 0, v21, vcc
    s_lshl_b32 s60, s28, 2
    s_add_u32 s60, s60, s32
    ds_read_b64 v[24:25], v65 offset:10240
    ds_read_b64 v[26:27], v65 offset:10248
    ds_read_b64 v[28:29], v64 offset:10272
    ds_read_b64 v[32:33], v65 offset:0
    ds_read_b64 v[34:35], v65 offset:8
    ds_read_b64 v[36:37], v64 offset:32
    ds_read_b64 v[40:41], v65 offset:1280
    ds_read_b64 v[42:43], v65 offset:1288
    ds_read_b64 v[44:45], v64 offset:1312
    ds_read_b64 v[48:49], v65 offset:2560
    ds_read_b64 v[50:51], v65 offset:2568
    ds_read_b64 v[52:53], v64 offset:2592
    s_waitcnt lgkmcnt(9)
    v_mfma_f32_32x32x16_bf16 v[240:255], v[24:27], v[16:19], 0
    v_mfma_f32_32x32x16_bf16 v[240:255], v[28:31], v[20:23], v[240:255]
    ds_read_b64 v[24:25], v65 offset:3840
    ds_read_b64 v[26:27], v65 offset:3848
    ds_read_b64 v[28:29], v64 offset:3872
    s_waitcnt lgkmcnt(9)
    v_mfma_f32_32x32x16_bf16 v[112:127], v[32:35], v[16:19], 0
    v_mfma_f32_32x32x16_bf16 v[112:127], v[36:39], v[20:23], v[112:127]
    ds_read_b64 v[32:33], v65 offset:5120
    ds_read_b64 v[34:35], v65 offset:5128
    ds_read_b64 v[36:37], v64 offset:5152
    s_waitcnt lgkmcnt(9)
    v_mfma_f32_32x32x16_bf16 v[128:143], v[40:43], v[16:19], 0
    v_mfma_f32_32x32x16_bf16 v[128:143], v[44:47], v[20:23], v[128:143]
    ds_read_b64 v[40:41], v65 offset:6400
    ds_read_b64 v[42:43], v65 offset:6408
    ds_read_b64 v[44:45], v64 offset:6432
    s_waitcnt lgkmcnt(9)
    v_mfma_f32_32x32x16_bf16 v[144:159], v[48:51], v[16:19], 0
    v_mfma_f32_32x32x16_bf16 v[144:159], v[52:55], v[20:23], v[144:159]
    v_mov_b32 v1, v127
    s_cmp_ge_u32 s60, 8
    s_cbranch_scc1 P2_V0
    v_mov_b32 v112, 0xff800000
    v_mov_b32 v113, 0xff800000
    v_mov_b32 v114, 0xff800000
    v_mov_b32 v115, 0xff800000
    v_mov_b32 v116, 0xff800000
    v_mov_b32 v117, 0xff800000
    v_mov_b32 v118, 0xff800000
    v_mov_b32 v119, 0xff800000
    v_mov_b32 v120, 0xff800000
    v_mov_b32 v121, 0xff800000
    v_mov_b32 v122, 0xff800000
    v_mov_b32 v123, 0xff800000
    v_mov_b32 v124, 0xff800000
    v_mov_b32 v125, 0xff800000
    v_mov_b32 v126, 0xff800000
    v_mov_b32 v127, 0xff800000
P2_V0:
    v_cndmask_b32 v112, v240, v112, s[66:67]
    v_cndmask_b32 v113, v241, v113, s[68:69]
    v_cndmask_b32 v114, v242, v114, s[70:71]
    v_cndmask_b32 v115, v243, v115, s[72:73]
    v_cndmask_b32 v116, v244, v116, s[74:75]
    v_cndmask_b32 v117, v245, v117, s[76:77]
    v_cndmask_b32 v118, v246, v118, s[78:79]
    v_cndmask_b32 v119, v247, v119, s[80:81]
    v_cndmask_b32 v120, v248, v120, s[82:83]
    v_cndmask_b32 v121, v249, v121, s[84:85]
    v_cndmask_b32 v122, v250, v122, s[86:87]
    v_cndmask_b32 v123, v251, v123, s[88:89]
    v_cndmask_b32 v124, v252, v124, s[90:91]
    v_cndmask_b32 v125, v253, v125, s[92:93]
    v_cndmask_b32 v126, v254, v126, s[94:95]
    v_cndmask_b32 v127, v255, v127, s[96:97]
    v_max3_f32 v60, v112, v113, v114
    v_max3_f32 v61, v116, v117, v118
    v_max3_f32 v62, v120, v121, v122
    v_max3_f32 v63, v124, v125, v126
    v_max_f32 v60, v60, v115
    v_max_f32 v61, v61, v119
    v_max_f32 v62, v62, v123
    v_max_f32 v63, v63, v127
    ds_read_b64 v[48:49], v65 offset:7680
    ds_read_b64 v[50:51], v65 offset:7688
    ds_read_b64 v[52:53], v64 offset:7712
    s_waitcnt lgkmcnt(9)
    v_mfma_f32_32x32x16_bf16 v[160:175], v[24:27], v[16:19], 0
    v_mfma_f32_32x32x16_bf16 v[160:175], v[28:31], v[20:23], v[160:175]
    v_mov_b32 v1, v143
    s_cmp_ge_u32 s60, 7
    s_cbranch_scc1 P2_V1
    v_mov_b32 v128, 0xff800000
    v_mov_b32 v129, 0xff800000
    v_mov_b32 v130, 0xff800000
    v_mov_b32 v131, 0xff800000
    v_mov_b32 v132, 0xff800000
    v_mov_b32 v133, 0xff800000
    v_mov_b32 v134, 0xff800000
    v_mov_b32 v135, 0xff800000
    v_mov_b32 v136, 0xff800000
    v_mov_b32 v137, 0xff800000
    v_mov_b32 v138, 0xff800000
    v_mov_b32 v139, 0xff800000
    v_mov_b32 v140, 0xff800000
    v_mov_b32 v141, 0xff800000
    v_mov_b32 v142, 0xff800000
    v_mov_b32 v143, 0xff800000
P2_V1:
    v_max3_f32 v60, v60, v128, v129
    v_max3_f32 v61, v61, v130, v131
    v_max3_f32 v62, v62, v132, v133
    v_max3_f32 v63, v63, v134, v135
    v_max3_f32 v60, v60, v136, v137
    v_max3_f32 v61, v61, v138, v139
    v_max3_f32 v62, v62, v140, v141
    v_max3_f32 v63, v63, v142, v143
    ds_read_b64 v[24:25], v65 offset:8960
    ds_read_b64 v[26:27], v65 offset:8968
    ds_read_b64 v[28:29], v64 offset:8992
    s_waitcnt lgkmcnt(9)
    v_mfma_f32_32x32x16_bf16 v[176:191], v[32:35], v[16:19], 0
    v_mfma_f32_32x32x16_bf16 v[176:191], v[36:39], v[20:23], v[176:191]
    v_mov_b32 v1, v159
    s_cmp_ge_u32 s60, 6
    s_cbranch_scc1 P2_V2
    v_mov_b32 v144, 0xff800000
    v_mov_b32 v145, 0xff800000
    v_mov_b32 v146, 0xff800000
    v_mov_b32 v147, 0xff800000
    v_mov_b32 v148, 0xff800000
    v_mov_b32 v149, 0xff800000
    v_mov_b32 v150, 0xff800000
    v_mov_b32 v151, 0xff800000
    v_mov_b32 v152, 0xff800000
    v_mov_b32 v153, 0xff800000
    v_mov_b32 v154, 0xff800000
    v_mov_b32 v155, 0xff800000
    v_mov_b32 v156, 0xff800000
    v_mov_b32 v157, 0xff800000
    v_mov_b32 v158, 0xff800000
    v_mov_b32 v159, 0xff800000
P2_V2:
    v_max3_f32 v60, v60, v144, v145
    v_max3_f32 v61, v61, v146, v147
    v_max3_f32 v62, v62, v148, v149
    v_max3_f32 v63, v63, v150, v151
    v_max3_f32 v60, v60, v152, v153
    v_max3_f32 v61, v61, v154, v155
    v_max3_f32 v62, v62, v156, v157
    v_max3_f32 v63, v63, v158, v159
    s_waitcnt lgkmcnt(6)
    v_mfma_f32_32x32x16_bf16 v[192:207], v[40:43], v[16:19], 0
    v_mfma_f32_32x32x16_bf16 v[192:207], v[44:47], v[20:23], v[192:207]
    v_mov_b32 v1, v175
    s_cmp_ge_u32 s60, 5
    s_cbranch_scc1 P2_V3
    v_mov_b32 v160, 0xff800000
    v_mov_b32 v161, 0xff800000
    v_mov_b32 v162, 0xff800000
    v_mov_b32 v163, 0xff800000
    v_mov_b32 v164, 0xff800000
    v_mov_b32 v165, 0xff800000
    v_mov_b32 v166, 0xff800000
    v_mov_b32 v167, 0xff800000
    v_mov_b32 v168, 0xff800000
    v_mov_b32 v169, 0xff800000
    v_mov_b32 v170, 0xff800000
    v_mov_b32 v171, 0xff800000
    v_mov_b32 v172, 0xff800000
    v_mov_b32 v173, 0xff800000
    v_mov_b32 v174, 0xff800000
    v_mov_b32 v175, 0xff800000
P2_V3:
    v_max3_f32 v60, v60, v160, v161
    v_max3_f32 v61, v61, v162, v163
    v_max3_f32 v62, v62, v164, v165
    v_max3_f32 v63, v63, v166, v167
    v_max3_f32 v60, v60, v168, v169
    v_max3_f32 v61, v61, v170, v171
    v_max3_f32 v62, v62, v172, v173
    v_max3_f32 v63, v63, v174, v175
    s_waitcnt lgkmcnt(3)
    v_mfma_f32_32x32x16_bf16 v[208:223], v[48:51], v[16:19], 0
    v_mfma_f32_32x32x16_bf16 v[208:223], v[52:55], v[20:23], v[208:223]
    v_mov_b32 v1, v191
    s_cmp_ge_u32 s60, 4
    s_cbranch_scc1 P2_V4
    v_mov_b32 v176, 0xff800000
    v_mov_b32 v177, 0xff800000
    v_mov_b32 v178, 0xff800000
    v_mov_b32 v179, 0xff800000
    v_mov_b32 v180, 0xff800000
    v_mov_b32 v181, 0xff800000
    v_mov_b32 v182, 0xff800000
    v_mov_b32 v183, 0xff800000
    v_mov_b32 v184, 0xff800000
    v_mov_b32 v185, 0xff800000
    v_mov_b32 v186, 0xff800000
    v_mov_b32 v187, 0xff800000
    v_mov_b32 v188, 0xff800000
    v_mov_b32 v189, 0xff800000
    v_mov_b32 v190, 0xff800000
    v_mov_b32 v191, 0xff800000
P2_V4:
    v_max3_f32 v60, v60, v176, v177
    v_max3_f32 v61, v61, v178, v179
    v_max3_f32 v62, v62, v180, v181
    v_max3_f32 v63, v63, v182, v183
    v_max3_f32 v60, v60, v184, v185
    v_max3_f32 v61, v61, v186, v187
    v_max3_f32 v62, v62, v188, v189
    v_max3_f32 v63, v63, v190, v191
    s_waitcnt lgkmcnt(0)
    v_mfma_f32_32x32x16_bf16 v[224:239], v[24:27], v[16:19], 0
    v_mfma_f32_32x32x16_bf16 v[224:239], v[28:31], v[20:23], v[224:239]
    v_mov_b32 v1, v207
    s_cmp_ge_u32 s60, 3
    s_cbranch_scc1 P2_V5
    v_mov_b32 v192, 0xff800000
    v_mov_b32 v193, 0xff800000
    v_mov_b32 v194, 0xff800000
    v_mov_b32 v195, 0xff800000
    v_mov_b32 v196, 0xff800000
    v_mov_b32 v197, 0xff800000
    v_mov_b32 v198, 0xff800000
    v_mov_b32 v199, 0xff800000
    v_mov_b32 v200, 0xff800000
    v_mov_b32 v201, 0xff800000
    v_mov_b32 v202, 0xff800000
    v_mov_b32 v203, 0xff800000
    v_mov_b32 v204, 0xff800000
    v_mov_b32 v205, 0xff800000
    v_mov_b32 v206, 0xff800000
    v_mov_b32 v207, 0xff800000
P2_V5:
    v_max3_f32 v60, v60, v192, v193
    v_max3_f32 v61, v61, v194, v195
    v_max3_f32 v62, v62, v196, v197
    v_max3_f32 v63, v63, v198, v199
    v_max3_f32 v60, v60, v200, v201
    v_max3_f32 v61, v61, v202, v203
    v_max3_f32 v62, v62, v204, v205
    v_max3_f32 v63, v63, v206, v207
    v_mov_b32 v1, v223
    s_cmp_ge_u32 s60, 2
    s_cbranch_scc1 P2_V6
    v_mov_b32 v208, 0xff800000
    v_mov_b32 v209, 0xff800000
    v_mov_b32 v210, 0xff800000
    v_mov_b32 v211, 0xff800000
    v_mov_b32 v212, 0xff800000
    v_mov_b32 v213, 0xff800000
    v_mov_b32 v214, 0xff800000
    v_mov_b32 v215, 0xff800000
    v_mov_b32 v216, 0xff800000
    v_mov_b32 v217, 0xff800000
    v_mov_b32 v218, 0xff800000
    v_mov_b32 v219, 0xff800000
    v_mov_b32 v220, 0xff800000
    v_mov_b32 v221, 0xff800000
    v_mov_b32 v222, 0xff800000
    v_mov_b32 v223, 0xff800000
P2_V6:
    v_max3_f32 v60, v60, v208, v209
    v_max3_f32 v61, v61, v210, v211
    v_max3_f32 v62, v62, v212, v213
    v_max3_f32 v63, v63, v214, v215
    v_max3_f32 v60, v60, v216, v217
    v_max3_f32 v61, v61, v218, v219
    v_max3_f32 v62, v62, v220, v221
    v_max3_f32 v63, v63, v222, v223
    s_cmp_ge_u32 s24, 4
    s_cbranch_scc1 P2_NOB0
    buffer_load_dwordx4 v[56:59], v5, s[36:39], s99 offen sc1
P2_NOB0:
    v_mov_b32 v1, v239
    s_cmp_ge_u32 s60, 1
    s_cbranch_scc1 P2_V7
    v_mov_b32 v224, 0xff800000
    v_mov_b32 v225, 0xff800000
    v_mov_b32 v226, 0xff800000
    v_mov_b32 v227, 0xff800000
    v_mov_b32 v228, 0xff800000
    v_mov_b32 v229, 0xff800000
    v_mov_b32 v230, 0xff800000
    v_mov_b32 v231, 0xff800000
    v_mov_b32 v232, 0xff800000
    v_mov_b32 v233, 0xff800000
    v_mov_b32 v234, 0xff800000
    v_mov_b32 v235, 0xff800000
    v_mov_b32 v236, 0xff800000
    v_mov_b32 v237, 0xff800000
    v_mov_b32 v238, 0xff800000
    v_mov_b32 v239, 0xff800000
P2_V7:
    v_max3_f32 v60, v60, v224, v225
    v_max3_f32 v61, v61, v226, v227
    v_max3_f32 v62, v62, v228, v229
    v_max3_f32 v63, v63, v230, v231
    v_max3_f32 v60, v60, v232, v233
    v_max3_f32 v61, v61, v234, v235
    v_max3_f32 v62, v62, v236, v237
    v_max3_f32 v63, v63, v238, v239
    v_max3_f32 v60, v60, v61, v62
    v_max_f32 v60, v60, v63
    v_mov_b32 v61, v60
    s_nop 1
    v_permlane32_swap_b32 v60, v61
    v_max_f32 v60, v60, v61
    s_mov_b32 s60, 0x3ea52b5c
    s_mov_b32 s61, 0x3ea52b5c
    v_mul_f32 v60, 0xbea52b5c, v60
    v_mov_b32 v61, v60
    s_setprio 0
    s_mov_b32 s70, 0
    s_mov_b32 s98, 0
    s_lshr_b32 s98, s24, 2
    v_pk_fma_f32 v[112:113], v[112:113], s[60:61], v[60:61]
    v_pk_fma_f32 v[114:115], v[114:115], s[60:61], v[60:61]
    v_pk_fma_f32 v[116:117], v[116:117], s[60:61], v[60:61]
    v_pk_fma_f32 v[118:119], v[118:119], s[60:61], v[60:61]
    v_pk_fma_f32 v[120:121], v[120:121], s[60:61], v[60:61]
    v_pk_fma_f32 v[122:123], v[122:123], s[60:61], v[60:61]
    v_pk_fma_f32 v[124:125], v[124:125], s[60:61], v[60:61]
    v_pk_fma_f32 v[126:127], v[126:127], s[60:61], v[60:61]
    v_exp_f32 v112, v112
    v_exp_f32 v113, v113
    v_exp_f32 v114, v114
    v_exp_f32 v115, v115
    v_exp_f32 v116, v116
    v_exp_f32 v117, v117
    v_exp_f32 v118, v118
    v_exp_f32 v119, v119
    v_exp_f32 v120, v120
    v_exp_f32 v121, v121
    v_exp_f32 v122, v122
    v_exp_f32 v123, v123
    v_exp_f32 v124, v124
    v_exp_f32 v125, v125
    v_exp_f32 v126, v126
    v_exp_f32 v127, v127
    v_cvt_pk_bf16_f32 v112, v112, v113
    v_cvt_pk_bf16_f32 v113, v114, v115
    v_cvt_pk_bf16_f32 v114, v116, v117
    v_cvt_pk_bf16_f32 v115, v118, v119
    v_cvt_pk_bf16_f32 v116, v120, v121
    v_cvt_pk_bf16_f32 v117, v122, v123
    v_cvt_pk_bf16_f32 v118, v124, v125
    v_cvt_pk_bf16_f32 v119, v126, v127
    v_bfi_b32 v240, v68, 0, v112
    v_and_b32 v112, v68, v112
    v_bfi_b32 v241, v69, 0, v113
    v_and_b32 v113, v69, v113
    v_bfi_b32 v242, v70, 0, v114
    v_and_b32 v114, v70, v114
    v_bfi_b32 v243, v71, 0, v115
    v_and_b32 v115, v71, v115
    v_bfi_b32 v244, v72, 0, v116
    v_and_b32 v116, v72, v116
    v_bfi_b32 v245, v73, 0, v117
    v_and_b32 v117, v73, v117
    v_bfi_b32 v246, v74, 0, v118
    v_and_b32 v118, v74, v118
    v_bfi_b32 v247, v75, 0, v119
    v_and_b32 v119, v75, v119
    v_pk_fma_f32 v[128:129], v[128:129], s[60:61], v[60:61]
    v_pk_fma_f32 v[130:131], v[130:131], s[60:61], v[60:61]
    v_pk_fma_f32 v[132:133], v[132:133], s[60:61], v[60:61]
    v_pk_fma_f32 v[134:135], v[134:135], s[60:61], v[60:61]
    v_pk_fma_f32 v[136:137], v[136:137], s[60:61], v[60:61]
    v_pk_fma_f32 v[138:139], v[138:139], s[60:61], v[60:61]
    v_pk_fma_f32 v[140:141], v[140:141], s[60:61], v[60:61]
    v_pk_fma_f32 v[142:143], v[142:143], s[60:61], v[60:61]
    v_exp_f32 v128, v128
    v_exp_f32 v129, v129
    v_exp_f32 v130, v130
    v_exp_f32 v131, v131
    v_exp_f32 v132, v132
    v_exp_f32 v133, v133
    v_exp_f32 v134, v134
    v_exp_f32 v135, v135
    v_exp_f32 v136, v136
    v_exp_f32 v137, v137
    v_exp_f32 v138, v138
    v_exp_f32 v139, v139
    v_exp_f32 v140, v140
    v_exp_f32 v141, v141
    v_exp_f32 v142, v142
    v_exp_f32 v143, v143
    v_cvt_pk_bf16_f32 v128, v128, v129
    v_cvt_pk_bf16_f32 v129, v130, v131
    v_cvt_pk_bf16_f32 v130, v132, v133
    v_cvt_pk_bf16_f32 v131, v134, v135
    v_cvt_pk_bf16_f32 v132, v136, v137
    v_cvt_pk_bf16_f32 v133, v138, v139
    v_cvt_pk_bf16_f32 v134, v140, v141
    v_cvt_pk_bf16_f32 v135, v142, v143
    s_cmp_eq_u32 s98, 1
    s_cbranch_scc1 P2_FC1
    s_waitcnt vmcnt(0)
    v_and_b32 v56, v56, v57
    v_and_b32 v58, v58, v59
    v_and_b32 v56, v56, v58
    v_cmp_ne_u32 vcc, 1, v56
    s_nop 1
    s_cmp_eq_u64 vcc, 0
    s_cbranch_scc1 P2_FC1_Y
    buffer_load_dwordx4 v[56:59], v5, s[36:39], s99 offen sc1
    s_branch P2_FC1
P2_FC1_Y:
    buffer_load_dwordx4 v[24:27], v9, s[52:55], s64 offen
    buffer_load_dwordx4 v[28:31], v9, s[52:55], s64 offen offset:640
    buffer_load_dwordx4 v[32:35], v12, s[56:59], s65 offen
    buffer_load_dwordx4 v[36:39], v13, s[56:59], s65 offen offset:16
    buffer_load_dwordx4 v[40:43], v12, s[56:59], s65 offen offset:1280
    buffer_load_dwordx4 v[44:47], v13, s[56:59], s65 offen offset:1296
    buffer_load_dwordx4 v[48:51], v10, s[56:59], s65 offen
    buffer_load_dwordx4 v[52:55], v11, s[56:59], s65 offen offset:16
    s_mov_b32 s98, 1
P2_FC1:
    v_mov_b32 v62, 32720
P2_VW:
    ds_read_b128 v[80:83], v62
    s_waitcnt lgkmcnt(0)
    v_and_b32 v80, v80, v81
    v_and_b32 v82, v82, v83
    v_and_b32 v80, v80, v82
    s_nop 0
    v_readfirstlane_b32 s69, v80
    s_add_u32 s70, s70, 1
    s_cmp_gt_u32 s70, 524288
    s_cbranch_scc1 P2_VWX
    s_cmp_lg_u32 s69, 1
    s_cbranch_scc1 P2_VW
P2_VWX:
    ds_read_b128 v[80:83], v66 offset:0
    ds_read_b128 v[84:87], v66 offset:32
    ds_read_b128 v[88:91], v66 offset:512
    v_pk_fma_f32 v[144:145], v[144:145], s[60:61], v[60:61]
    v_pk_fma_f32 v[146:147], v[146:147], s[60:61], v[60:61]
    v_pk_fma_f32 v[148:149], v[148:149], s[60:61], v[60:61]
    v_pk_fma_f32 v[150:151], v[150:151], s[60:61], v[60:61]
    v_pk_fma_f32 v[152:153], v[152:153], s[60:61], v[60:61]
    v_pk_fma_f32 v[154:155], v[154:155], s[60:61], v[60:61]
    v_pk_fma_f32 v[156:157], v[156:157], s[60:61], v[60:61]
    v_pk_fma_f32 v[158:159], v[158:159], s[60:61], v[60:61]
    s_waitcnt lgkmcnt(2)
    v_mfma_f32_32x32x16_bf16 v[96:111], v[80:83], v[112:115], 0
    ds_read_b128 v[92:95], v66 offset:544
    v_exp_f32 v144, v144
    v_exp_f32 v145, v145
    v_exp_f32 v146, v146
    v_exp_f32 v147, v147
    v_exp_f32 v148, v148
    v_exp_f32 v149, v149
    v_exp_f32 v150, v150
    v_exp_f32 v151, v151
    s_waitcnt lgkmcnt(2)
    v_mfma_f32_32x32x16_bf16 v[96:111], v[84:87], v[116:119], v[96:111]
    ds_read_b128 v[80:83], v66 offset:64
    v_exp_f32 v152, v152
    v_exp_f32 v153, v153
    v_exp_f32 v154, v154
    v_exp_f32 v155, v155
    v_exp_f32 v156, v156
    v_exp_f32 v157, v157
    v_exp_f32 v158, v158
    v_exp_f32 v159, v159
    s_waitcnt lgkmcnt(2)
    v_mfma_f32_32x32x16_bf16 v[96:111], v[88:91], v[240:243], v[96:111]
    ds_read_b128 v[84:87], v66 offset:96
    v_cvt_pk_bf16_f32 v144, v144, v145
    v_cvt_pk_bf16_f32 v145, v146, v147
    v_cvt_pk_bf16_f32 v146, v148, v149
    v_cvt_pk_bf16_f32 v147, v150, v151
    v_cvt_pk_bf16_f32 v148, v152, v153
    v_cvt_pk_bf16_f32 v149, v154, v155
    v_cvt_pk_bf16_f32 v150, v156, v157
    v_cvt_pk_bf16_f32 v151, v158, v159
    v_pk_fma_f32 v[160:161], v[160:161], s[60:61], v[60:61]
    v_pk_fma_f32 v[162:163], v[162:163], s[60:61], v[60:61]
    v_pk_fma_f32 v[164:165], v[164:165], s[60:61], v[60:61]
    v_pk_fma_f32 v[166:167], v[166:167], s[60:61], v[60:61]
    v_pk_fma_f32 v[168:169], v[168:169], s[60:61], v[60:61]
    v_pk_fma_f32 v[170:171], v[170:171], s[60:61], v[60:61]
    v_pk_fma_f32 v[172:173], v[172:173], s[60:61], v[60:61]
    v_pk_fma_f32 v[174:175], v[174:175], s[60:61], v[60:61]
    s_waitcnt lgkmcnt(2)
    v_mfma_f32_32x32x16_bf16 v[96:111], v[92:95], v[244:247], v[96:111]
    ds_read_b128 v[88:91], v66 offset:128
    v_exp_f32 v160, v160
    v_exp_f32 v161, v161
    v_exp_f32 v162, v162
    v_exp_f32 v163, v163
    v_exp_f32 v164, v164
    v_exp_f32 v165, v165
    v_exp_f32 v166, v166
    v_exp_f32 v167, v167
    s_waitcnt lgkmcnt(2)
    v_mfma_f32_32x32x16_bf16 v[96:111], v[80:83], v[128:131], v[96:111]
    ds_read_b128 v[92:95], v66 offset:160
    v_exp_f32 v168, v168
    v_exp_f32 v169, v169
    v_exp_f32 v170, v170
    v_exp_f32 v171, v171
    v_exp_f32 v172, v172
    v_exp_f32 v173, v173
    v_exp_f32 v174, v174
    v_exp_f32 v175, v175
    s_waitcnt lgkmcnt(2)
    v_mfma_f32_32x32x16_bf16 v[96:111], v[84:87], v[132:135], v[96:111]
    ds_read_b128 v[80:83], v66 offset:192
    v_cvt_pk_bf16_f32 v160, v160, v161
    v_cvt_pk_bf16_f32 v161, v162, v163
    v_cvt_pk_bf16_f32 v162, v164, v165
    v_cvt_pk_bf16_f32 v163, v166, v167
    v_cvt_pk_bf16_f32 v164, v168, v169
    v_cvt_pk_bf16_f32 v165, v170, v171
    v_cvt_pk_bf16_f32 v166, v172, v173
    v_cvt_pk_bf16_f32 v167, v174, v175
    s_cmp_eq_u32 s98, 1
    s_cbranch_scc1 P2_FC3
    s_waitcnt vmcnt(0)
    v_and_b32 v56, v56, v57
    v_and_b32 v58, v58, v59
    v_and_b32 v56, v56, v58
    v_cmp_ne_u32 vcc, 1, v56
    s_nop 1
    s_cmp_eq_u64 vcc, 0
    s_cbranch_scc1 P2_FC3_Y
    buffer_load_dwordx4 v[56:59], v5, s[36:39], s99 offen sc1
    s_branch P2_FC3
P2_FC3_Y:
    buffer_load_dwordx4 v[24:27], v9, s[52:55], s64 offen
    buffer_load_dwordx4 v[28:31], v9, s[52:55], s64 offen offset:640
    buffer_load_dwordx4 v[32:35], v12, s[56:59], s65 offen
    buffer_load_dwordx4 v[36:39], v13, s[56:59], s65 offen offset:16
    buffer_load_dwordx4 v[40:43], v12, s[56:59], s65 offen offset:1280
    buffer_load_dwordx4 v[44:47], v13, s[56:59], s65 offen offset:1296
    buffer_load_dwordx4 v[48:51], v10, s[56:59], s65 offen
    buffer_load_dwordx4 v[52:55], v11, s[56:59], s65 offen offset:16
    s_mov_b32 s98, 1
P2_FC3:
    v_pk_fma_f32 v[176:177], v[176:177], s[60:61], v[60:61]
    v_pk_fma_f32 v[178:179], v[178:179], s[60:61], v[60:61]
    v_pk_fma_f32 v[180:181], v[180:181], s[60:61], v[60:61]
    v_pk_fma_f32 v[182:183], v[182:183], s[60:61], v[60:61]
    v_pk_fma_f32 v[184:185], v[184:185], s[60:61], v[60:61]
    v_pk_fma_f32 v[186:187], v[186:187], s[60:61], v[60:61]
    v_pk_fma_f32 v[188:189], v[188:189], s[60:61], v[60:61]
    v_pk_fma_f32 v[190:191], v[190:191], s[60:61], v[60:61]
    s_waitcnt lgkmcnt(2)
    v_mfma_f32_32x32x16_bf16 v[96:111], v[88:91], v[144:147], v[96:111]
    ds_read_b128 v[84:87], v66 offset:224
    v_exp_f32 v176, v176
    v_exp_f32 v177, v177
    v_exp_f32 v178, v178
    v_exp_f32 v179, v179
    v_exp_f32 v180, v180
    v_exp_f32 v181, v181
    v_exp_f32 v182, v182
    v_exp_f32 v183, v183
    s_waitcnt lgkmcnt(2)
    v_mfma_f32_32x32x16_bf16 v[96:111], v[92:95], v[148:151], v[96:111]
    ds_read_b128 v[88:91], v66 offset:256
    v_exp_f32 v184, v184
    v_exp_f32 v185, v185
    v_exp_f32 v186, v186
    v_exp_f32 v187, v187
    v_exp_f32 v188, v188
    v_exp_f32 v189, v189
    v_exp_f32 v190, v190
    v_exp_f32 v191, v191
    s_waitcnt lgkmcnt(2)
    v_mfma_f32_32x32x16_bf16 v[96:111], v[80:83], v[160:163], v[96:111]
    ds_read_b128 v[92:95], v66 offset:288
    v_cvt_pk_bf16_f32 v176, v176, v177
    v_cvt_pk_bf16_f32 v177, v178, v179
    v_cvt_pk_bf16_f32 v178, v180, v181
    v_cvt_pk_bf16_f32 v179, v182, v183
    v_cvt_pk_bf16_f32 v180, v184, v185
    v_cvt_pk_bf16_f32 v181, v186, v187
    v_cvt_pk_bf16_f32 v182, v188, v189
    v_cvt_pk_bf16_f32 v183, v190, v191
    v_pk_fma_f32 v[192:193], v[192:193], s[60:61], v[60:61]
    v_pk_fma_f32 v[194:195], v[194:195], s[60:61], v[60:61]
    v_pk_fma_f32 v[196:197], v[196:197], s[60:61], v[60:61]
    v_pk_fma_f32 v[198:199], v[198:199], s[60:61], v[60:61]
    v_pk_fma_f32 v[200:201], v[200:201], s[60:61], v[60:61]
    v_pk_fma_f32 v[202:203], v[202:203], s[60:61], v[60:61]
    v_pk_fma_f32 v[204:205], v[204:205], s[60:61], v[60:61]
    v_pk_fma_f32 v[206:207], v[206:207], s[60:61], v[60:61]
    s_waitcnt lgkmcnt(2)
    v_mfma_f32_32x32x16_bf16 v[96:111], v[84:87], v[164:167], v[96:111]
    ds_read_b128 v[80:83], v66 offset:320
    v_exp_f32 v192, v192
    v_exp_f32 v193, v193
    v_exp_f32 v194, v194
    v_exp_f32 v195, v195
    v_exp_f32 v196, v196
    v_exp_f32 v197, v197
    v_exp_f32 v198, v198
    v_exp_f32 v199, v199
    s_waitcnt lgkmcnt(2)
    v_mfma_f32_32x32x16_bf16 v[96:111], v[88:91], v[176:179], v[96:111]
    ds_read_b128 v[84:87], v66 offset:352
    v_exp_f32 v200, v200
    v_exp_f32 v201, v201
    v_exp_f32 v202, v202
    v_exp_f32 v203, v203
    v_exp_f32 v204, v204
    v_exp_f32 v205, v205
    v_exp_f32 v206, v206
    v_exp_f32 v207, v207
    s_waitcnt lgkmcnt(2)
    v_mfma_f32_32x32x16_bf16 v[96:111], v[92:95], v[180:183], v[96:111]
    ds_read_b128 v[88:91], v66 offset:384
    v_cvt_pk_bf16_f32 v192, v192, v193
    v_cvt_pk_bf16_f32 v193, v194, v195
    v_cvt_pk_bf16_f32 v194, v196, v197
    v_cvt_pk_bf16_f32 v195, v198, v199
    v_cvt_pk_bf16_f32 v196, v200, v201
    v_cvt_pk_bf16_f32 v197, v202, v203
    v_cvt_pk_bf16_f32 v198, v204, v205
    v_cvt_pk_bf16_f32 v199, v206, v207
    s_cmp_eq_u32 s98, 1
    s_cbranch_scc1 P2_FC5
    s_waitcnt vmcnt(0)
    v_and_b32 v56, v56, v57
    v_and_b32 v58, v58, v59
    v_and_b32 v56, v56, v58
    v_cmp_ne_u32 vcc, 1, v56
    s_nop 1
    s_cmp_eq_u64 vcc, 0
    s_cbranch_scc1 P2_FC5_Y
    buffer_load_dwordx4 v[56:59], v5, s[36:39], s99 offen sc1
    s_branch P2_FC5
P2_FC5_Y:
    buffer_load_dwordx4 v[24:27], v9, s[52:55], s64 offen
    buffer_load_dwordx4 v[28:31], v9, s[52:55], s64 offen offset:640
    buffer_load_dwordx4 v[32:35], v12, s[56:59], s65 offen
    buffer_load_dwordx4 v[36:39], v13, s[56:59], s65 offen offset:16
    buffer_load_dwordx4 v[40:43], v12, s[56:59], s65 offen offset:1280
    buffer_load_dwordx4 v[44:47], v13, s[56:59], s65 offen offset:1296
    buffer_load_dwordx4 v[48:51], v10, s[56:59], s65 offen
    buffer_load_dwordx4 v[52:55], v11, s[56:59], s65 offen offset:16
    s_mov_b32 s98, 1
P2_FC5:
    v_pk_fma_f32 v[208:209], v[208:209], s[60:61], v[60:61]
    v_pk_fma_f32 v[210:211], v[210:211], s[60:61], v[60:61]
    v_pk_fma_f32 v[212:213], v[212:213], s[60:61], v[60:61]
    v_pk_fma_f32 v[214:215], v[214:215], s[60:61], v[60:61]
    v_pk_fma_f32 v[216:217], v[216:217], s[60:61], v[60:61]
    v_pk_fma_f32 v[218:219], v[218:219], s[60:61], v[60:61]
    v_pk_fma_f32 v[220:221], v[220:221], s[60:61], v[60:61]
    v_pk_fma_f32 v[222:223], v[222:223], s[60:61], v[60:61]
    s_waitcnt lgkmcnt(2)
    v_mfma_f32_32x32x16_bf16 v[96:111], v[80:83], v[192:195], v[96:111]
    ds_read_b128 v[92:95], v66 offset:416
    v_exp_f32 v208, v208
    v_exp_f32 v209, v209
    v_exp_f32 v210, v210
    v_exp_f32 v211, v211
    v_exp_f32 v212, v212
    v_exp_f32 v213, v213
    v_exp_f32 v214, v214
    v_exp_f32 v215, v215
    s_waitcnt lgkmcnt(2)
    v_mfma_f32_32x32x16_bf16 v[96:111], v[84:87], v[196:199], v[96:111]
    ds_read_b128 v[80:83], v66 offset:448
    v_exp_f32 v216, v216
    v_exp_f32 v217, v217
    v_exp_f32 v218, v218
    v_exp_f32 v219, v219
    v_exp_f32 v220, v220
    v_exp_f32 v221, v221
    v_exp_f32 v222, v222
    v_exp_f32 v223, v223
    v_cvt_pk_bf16_f32 v208, v208, v209
    v_cvt_pk_bf16_f32 v209, v210, v211
    v_cvt_pk_bf16_f32 v210, v212, v213
    v_cvt_pk_bf16_f32 v211, v214, v215
    v_cvt_pk_bf16_f32 v212, v216, v217
    v_cvt_pk_bf16_f32 v213, v218, v219
    v_cvt_pk_bf16_f32 v214, v220, v221
    v_cvt_pk_bf16_f32 v215, v222, v223
    v_pk_fma_f32 v[224:225], v[224:225], s[60:61], v[60:61]
    v_pk_fma_f32 v[226:227], v[226:227], s[60:61], v[60:61]
    v_pk_fma_f32 v[228:229], v[228:229], s[60:61], v[60:61]
    v_pk_fma_f32 v[230:231], v[230:231], s[60:61], v[60:61]
    v_pk_fma_f32 v[232:233], v[232:233], s[60:61], v[60:61]
    v_pk_fma_f32 v[234:235], v[234:235], s[60:61], v[60:61]
    v_pk_fma_f32 v[236:237], v[236:237], s[60:61], v[60:61]
    v_pk_fma_f32 v[238:239], v[238:239], s[60:61], v[60:61]
    s_waitcnt lgkmcnt(2)
    v_mfma_f32_32x32x16_bf16 v[96:111], v[88:91], v[208:211], v[96:111]
    ds_read_b128 v[84:87], v66 offset:480
    v_exp_f32 v224, v224
    v_exp_f32 v225, v225
    v_exp_f32 v226, v226
    v_exp_f32 v227, v227
    v_exp_f32 v228, v228
    v_exp_f32 v229, v229
    v_exp_f32 v230, v230
    v_exp_f32 v231, v231
    s_waitcnt lgkmcnt(2)
    v_mfma_f32_32x32x16_bf16 v[96:111], v[92:95], v[212:215], v[96:111]
    v_exp_f32 v232, v232
    v_exp_f32 v233, v233
    v_exp_f32 v234, v234
    v_exp_f32 v235, v235
    v_exp_f32 v236, v236
    v_exp_f32 v237, v237
    v_exp_f32 v238, v238
    v_exp_f32 v239, v239
    v_cvt_pk_bf16_f32 v224, v224, v225
    v_cvt_pk_bf16_f32 v225, v226, v227
    v_cvt_pk_bf16_f32 v226, v228, v229
    v_cvt_pk_bf16_f32 v227, v230, v231
    v_cvt_pk_bf16_f32 v228, v232, v233
    v_cvt_pk_bf16_f32 v229, v234, v235
    v_cvt_pk_bf16_f32 v230, v236, v237
    v_cvt_pk_bf16_f32 v231, v238, v239
    s_waitcnt lgkmcnt(1)
    v_mfma_f32_32x32x16_bf16 v[96:111], v[80:83], v[224:227], v[96:111]
    s_waitcnt lgkmcnt(0)
    v_mfma_f32_32x32x16_bf16 v[96:111], v[84:87], v[228:231], v[96:111]
    s_mov_b32 s97, 0
    s_cmp_eq_u32 s98, 1
    s_cbranch_scc1 P2_FCL
P2_FCL_R:
    s_waitcnt vmcnt(0)
    v_and_b32 v56, v56, v57
    v_and_b32 v58, v58, v59
    v_and_b32 v56, v56, v58
    v_cmp_ne_u32 vcc, 1, v56
    s_nop 1
    s_cmp_eq_u64 vcc, 0
    s_cbranch_scc1 P2_FCL_Y
    buffer_load_dwordx4 v[56:59], v5, s[36:39], s99 offen sc1
    s_add_u32 s97, s97, 1
    s_cmp_lt_u32 s97, 65536
    s_cbranch_scc1 P2_FCL_R
P2_FCL_Y:
    buffer_load_dwordx4 v[24:27], v9, s[52:55], s64 offen
    buffer_load_dwordx4 v[28:31], v9, s[52:55], s64 offen offset:640
    buffer_load_dwordx4 v[32:35], v12, s[56:59], s65 offen
    buffer_load_dwordx4 v[36:39], v13, s[56:59], s65 offen offset:16
    buffer_load_dwordx4 v[40:43], v12, s[56:59], s65 offen offset:1280
    buffer_load_dwordx4 v[44:47], v13, s[56:59], s65 offen offset:1296
    buffer_load_dwordx4 v[48:51], v10, s[56:59], s65 offen
    buffer_load_dwordx4 v[52:55], v11, s[56:59], s65 offen offset:16
    s_mov_b32 s98, 1
P2_FCL:
    s_mul_i32 s60, s32, 2560
    s_add_u32 s60, s60, 65536
    v_bfe_u32 v6, v3, 4, 1
    v_mul_u32_u24 v6, 1280, v6
    v_lshl_add_u32 v6, v77, 4, v6
    v_add_u32 v6, s60, v6
    s_mul_i32 s61, s31, 20
    v_lshlrev_b32 v7, 2, v4
    v_add_u32 v7, s61, v7
    v_lshrrev_b32 v8, 3, v7
    v_lshl_add_u32 v8, v8, 8, v6
    v_and_b32 v63, 4, v7
    v_lshl_add_u32 v8, v63, 1, v8
    v_rcp_f32 v62, v108
    s_nop 0
    v_mul_f32 v96, v96, v62
    v_mul_f32 v97, v97, v62
    v_mul_f32 v98, v98, v62
    v_mul_f32 v99, v99, v62
    v_mul_f32 v100, v100, v62
    v_mul_f32 v101, v101, v62
    v_mul_f32 v102, v102, v62
    v_mul_f32 v103, v103, v62
    v_mul_f32 v104, v104, v62
    v_mul_f32 v105, v105, v62
    v_mul_f32 v106, v106, v62
    v_mul_f32 v107, v107, v62
    v_cvt_pk_bf16_f32 v92, v96, v97
    v_cvt_pk_bf16_f32 v93, v98, v99
    v_cvt_pk_bf16_f32 v94, v100, v101
    v_cvt_pk_bf16_f32 v95, v102, v103
    v_cvt_pk_bf16_f32 v96, v104, v105
    v_cvt_pk_bf16_f32 v97, v106, v107
    ds_write_b64 v8, v[92:93]
    ds_write_b64 v8, v[94:95] offset:256
    s_mov_b32 exec_hi, 0
    ds_write_b64 v8, v[96:97] offset:512
    s_mov_b32 exec_hi, -1
    s_cmp_ge_u32 s24, 4
    s_cbranch_scc1 P2_NOB
    s_waitcnt vmcnt(0)
    v_cvt_pk_bf16_f32 v80, v32, v33
    v_cvt_pk_bf16_f32 v81, v34, v35
    v_cvt_pk_bf16_f32 v82, v36, v37
    v_cvt_pk_bf16_f32 v83, v38, v39
    v_cvt_pk_bf16_f32 v84, v40, v41
    v_cvt_pk_bf16_f32 v85, v42, v43
    v_cvt_pk_bf16_f32 v86, v44, v45
    v_cvt_pk_bf16_f32 v87, v46, v47
    v_cvt_pk_bf16_f32 v88, v48, v49
    v_cvt_pk_bf16_f32 v89, v50, v51
    v_cvt_pk_bf16_f32 v90, v52, v53
    v_cvt_pk_bf16_f32 v91, v54, v55
    v_mfma_f32_16x16x32_bf16 v[112:115], v[80:83], v[24:27], 0
    v_mfma_f32_16x16x32_bf16 v[116:119], v[84:87], v[24:27], 0
    v_mfma_f32_16x16x32_bf16 v[120:123], v[88:91], v[24:27], 0
    v_mfma_f32_16x16x32_bf16 v[124:127], v[80:83], v[28:31], 0
    v_mfma_f32_16x16x32_bf16 v[128:131], v[84:87], v[28:31], 0
    v_mfma_f32_16x16x32_bf16 v[132:135], v[88:91], v[28:31], 0
    s_add_u32 s64, s64, 81920
    s_add_u32 s65, s65, 1680
    buffer_load_dwordx4 v[24:27], v9, s[52:55], s64 offen
    buffer_load_dwordx4 v[28:31], v9, s[52:55], s64 offen offset:640
    buffer_load_dwordx4 v[32:35], v12, s[56:59], s65 offen
    buffer_load_dwordx4 v[36:39], v13, s[56:59], s65 offen offset:16
    buffer_load_dwordx4 v[40:43], v12, s[56:59], s65 offen offset:1280
    buffer_load_dwordx4 v[44:47], v13, s[56:59], s65 offen offset:1296
    buffer_load_dwordx4 v[48:51], v10, s[56:59], s65 offen
    buffer_load_dwordx4 v[52:55], v11, s[56:59], s65 offen offset:16
    v_lshlrev_b32 v7, 2, v15
    v_add_u32 v7, s61, v7
    v_lshlrev_b32 v6, 4, v77
    v_add_u32 v6, s60, v6
    v_lshrrev_b32 v8, 3, v7
    v_lshl_add_u32 v8, v8, 8, v6
    v_and_b32 v63, 4, v7
    v_lshl_add_u32 v8, v63, 1, v8
    v_add_f32 v62, 0x358637bd, v120
    v_add_f32 v63, 0x358637bd, v132
    v_rcp_f32 v62, v62
    v_rcp_f32 v63, v63
    v_mul_f32 v112, v112, v62
    v_mul_f32 v113, v113, v62
    v_mul_f32 v114, v114, v62
    v_mul_f32 v115, v115, v62
    v_mul_f32 v116, v116, v62
    v_mul_f32 v117, v117, v62
    v_mul_f32 v118, v118, v62
    v_mul_f32 v119, v119, v62
    v_cvt_pk_bf16_f32 v144, v112, v113
    v_cvt_pk_bf16_f32 v145, v114, v115
    v_cvt_pk_bf16_f32 v146, v116, v117
    v_cvt_pk_bf16_f32 v147, v118, v119
    v_mul_f32 v124, v124, v63
    v_mul_f32 v125, v125, v63
    v_mul_f32 v126, v126, v63
    v_mul_f32 v127, v127, v63
    v_mul_f32 v128, v128, v63
    v_mul_f32 v129, v129, v63
    v_mul_f32 v130, v130, v63
    v_mul_f32 v131, v131, v63
    v_cvt_pk_bf16_f32 v148, v124, v125
    v_cvt_pk_bf16_f32 v149, v126, v127
    v_cvt_pk_bf16_f32 v150, v128, v129
    v_cvt_pk_bf16_f32 v151, v130, v131
    ds_write_b64 v8, v[144:145] offset:10240
    ds_write_b64 v8, v[148:149] offset:11520
    s_mov_b64 exec, 0xffff
    ds_write_b64 v8, v[146:147] offset:10752
    ds_write_b64 v8, v[150:151] offset:12032
    s_mov_b64 exec, -1
    s_mov_b32 s61, 20
    s_waitcnt vmcnt(0)
    v_cvt_pk_bf16_f32 v80, v32, v33
    v_cvt_pk_bf16_f32 v81, v34, v35
    v_cvt_pk_bf16_f32 v82, v36, v37
    v_cvt_pk_bf16_f32 v83, v38, v39
    v_cvt_pk_bf16_f32 v84, v40, v41
    v_cvt_pk_bf16_f32 v85, v42, v43
    v_cvt_pk_bf16_f32 v86, v44, v45
    v_cvt_pk_bf16_f32 v87, v46, v47
    v_cvt_pk_bf16_f32 v88, v48, v49
    v_cvt_pk_bf16_f32 v89, v50, v51
    v_cvt_pk_bf16_f32 v90, v52, v53
    v_cvt_pk_bf16_f32 v91, v54, v55
    v_mfma_f32_16x16x32_bf16 v[112:115], v[80:83], v[24:27], 0
    v_mfma_f32_16x16x32_bf16 v[116:119], v[84:87], v[24:27], 0
    v_mfma_f32_16x16x32_bf16 v[120:123], v[88:91], v[24:27], 0
    v_mfma_f32_16x16x32_bf16 v[124:127], v[80:83], v[28:31], 0
    v_mfma_f32_16x16x32_bf16 v[128:131], v[84:87], v[28:31], 0
    v_mfma_f32_16x16x32_bf16 v[132:135], v[88:91], v[28:31], 0
    v_lshlrev_b32 v7, 2, v15
    v_add_u32 v7, s61, v7
    v_lshlrev_b32 v6, 4, v77
    v_add_u32 v6, s60, v6
    v_lshrrev_b32 v8, 3, v7
    v_lshl_add_u32 v8, v8, 8, v6
    v_and_b32 v63, 4, v7
    v_lshl_add_u32 v8, v63, 1, v8
    v_add_f32 v62, 0x358637bd, v120
    v_add_f32 v63, 0x358637bd, v132
    v_rcp_f32 v62, v62
    v_rcp_f32 v63, v63
    v_mul_f32 v112, v112, v62
    v_mul_f32 v113, v113, v62
    v_mul_f32 v114, v114, v62
    v_mul_f32 v115, v115, v62
    v_mul_f32 v116, v116, v62
    v_mul_f32 v117, v117, v62
    v_mul_f32 v118, v118, v62
    v_mul_f32 v119, v119, v62
    v_cvt_pk_bf16_f32 v144, v112, v113
    v_cvt_pk_bf16_f32 v145, v114, v115
    v_cvt_pk_bf16_f32 v146, v116, v117
    v_cvt_pk_bf16_f32 v147, v118, v119
    v_mul_f32 v124, v124, v63
    v_mul_f32 v125, v125, v63
    v_mul_f32 v126, v126, v63
    v_mul_f32 v127, v127, v63
    v_mul_f32 v128, v128, v63
    v_mul_f32 v129, v129, v63
    v_mul_f32 v130, v130, v63
    v_mul_f32 v131, v131, v63
    v_cvt_pk_bf16_f32 v148, v124, v125
    v_cvt_pk_bf16_f32 v149, v126, v127
    v_cvt_pk_bf16_f32 v150, v128, v129
    v_cvt_pk_bf16_f32 v151, v130, v131
    ds_write_b64 v8, v[144:145] offset:10240
    ds_write_b64 v8, v[148:149] offset:11520
    s_mov_b64 exec, 0xffff
    ds_write_b64 v8, v[146:147] offset:10752
    ds_write_b64 v8, v[150:151] offset:12032
    s_mov_b64 exec, -1
P2_NOB:
    s_mul_i32 s60, s24, 1280
    s_add_u32 s60, s60, 65536
    v_add_u32 v6, s60, v5
    s_lshl_b32 s60, s28, 3
    s_add_u32 s60, s60, s24
    s_mul_i32 s60, s60, 40960
    s_mul_i32 s61, s25, 1280
    s_add_u32 s60, s60, s61
    s_add_u32 s60, s60, 10493952
    s_add_u32 s61, s60, 20480
    s_and_b32 s66, s2, 1
    s_lshl_b32 s66, s66, 2
    s_lshr_b32 s67, s2, 3
    s_and_b32 s67, s67, 3
    s_add_u32 s66, s66, s67
    s_mul_i32 s66, s66, 204800
    s_and_b32 s67, s24, 3
    s_mul_i32 s69, s67, 10240
    s_add_u32 s66, s66, s69
    s_add_u32 s66, s66, 15736832
    s_mul_i32 s67, s67, 19456
    s_add_u32 s67, s67, 86016
    s_lshr_b32 s68, s24, 2
    s_cmp_ge_u32 s24, 4
    s_cbranch_scc1 P2_NOPRE
    s_add_u32 m0, s67, 0
    s_add_u32 s69, s66, 47104
    buffer_load_dwordx4 v5, s[36:39], s69 offen lds
    s_add_u32 m0, s67, 1024
    s_add_u32 s69, s66, 88064
    buffer_load_dwordx4 v5, s[36:39], s69 offen lds
    s_add_u32 m0, s67, 2048
    s_add_u32 s69, s66, 129024
    buffer_load_dwordx4 v5, s[36:39], s69 offen lds
    s_add_u32 m0, s67, 3072
    s_add_u32 s69, s66, 169984
    buffer_load_dwordx4 v5, s[36:39], s69 offen lds
    s_add_u32 m0, s67, 4096
    s_add_u32 s69, s66, 7168
    buffer_load_dwordx4 v5, s[36:39], s69 offen lds
    s_add_u32 m0, s67, 5120
    s_add_u32 s69, s66, 48128
    buffer_load_dwordx4 v5, s[36:39], s69 offen lds
    s_add_u32 m0, s67, 6144
    s_add_u32 s69, s66, 89088
    buffer_load_dwordx4 v5, s[36:39], s69 offen lds
    s_add_u32 m0, s67, 7168
    s_add_u32 s69, s66, 130048
    buffer_load_dwordx4 v5, s[36:39], s69 offen lds
    s_add_u32 m0, s67, 8192
    s_add_u32 s69, s66, 171008
    buffer_load_dwordx4 v5, s[36:39], s69 offen lds
    s_add_u32 m0, s67, 9216
    s_add_u32 s69, s66, 8192
    buffer_load_dwordx4 v5, s[36:39], s69 offen lds
    s_add_u32 m0, s67, 10240
    s_add_u32 s69, s66, 49152
    buffer_load_dwordx4 v5, s[36:39], s69 offen lds
    s_add_u32 m0, s67, 11264
    s_add_u32 s69, s66, 90112
    buffer_load_dwordx4 v5, s[36:39], s69 offen lds
    s_add_u32 m0, s67, 12288
    s_add_u32 s69, s66, 131072
    buffer_load_dwordx4 v5, s[36:39], s69 offen lds
    s_add_u32 m0, s67, 13312
    s_add_u32 s69, s66, 172032
    buffer_load_dwordx4 v5, s[36:39], s69 offen lds
    s_add_u32 m0, s67, 14336
    s_add_u32 s69, s66, 9216
    buffer_load_dwordx4 v5, s[36:39], s69 offen lds
    s_add_u32 m0, s67, 15360
    s_add_u32 s69, s66, 50176
    buffer_load_dwordx4 v5, s[36:39], s69 offen lds
    s_add_u32 m0, s67, 16384
    s_add_u32 s69, s66, 91136
    buffer_load_dwordx4 v5, s[36:39], s69 offen lds
    s_add_u32 m0, s67, 17408
    s_add_u32 s69, s66, 132096
    buffer_load_dwordx4 v5, s[36:39], s69 offen lds
    s_add_u32 m0, s67, 18432
    s_add_u32 s69, s66, 173056
    buffer_load_dwordx4 v5, s[36:39], s69 offen lds
P2_NOPRE:
    s_waitcnt lgkmcnt(0)
    s_barrier
    ds_read_b128 v[16:19], v6
    ds_read_b128 v[20:23], v6 offset:10240
    ds_read_b128 v[24:27], v6 offset:1024
    ds_read_b128 v[28:31], v6 offset:11264
    s_waitcnt lgkmcnt(2)
    buffer_store_dwordx4 v[16:19], v5, s[36:39], s60 offen sc1
    buffer_store_dwordx4 v[20:23], v5, s[36:39], s61 offen sc1
    s_waitcnt lgkmcnt(0)
    s_mov_b64 exec, 0xffff
    buffer_store_dwordx4 v[24:27], v5, s[36:39], s60 offen offset:1024 sc1
    buffer_store_dwordx4 v[28:31], v5, s[36:39], s61 offen offset:1024 sc1
    s_mov_b64 exec, -1
    s_and_b32 s60, s2, 7
    s_lshr_b32 s61, s2, 3
    s_and_b32 s31, s60, 1
    s_lshl_b32 s31, s31, 2
    s_and_b32 s62, s61, 3
    s_add_u32 s31, s31, s62
    s_lshr_b32 s32, s60, 1
    s_lshl_b32 s32, s32, 3
    s_lshr_b32 s62, s61, 2
    s_add_u32 s32, s32, s62
    s_and_b32 s26, s24, 3
    s_lshr_b32 s33, s24, 2
    v_lshlrev_b32 v3, 4, v2
    v_add_u32 v4, 40960, v3
    v_add_u32 v5, 81920, v3
    v_add_u32 v6, 122880, v3
    v_add_u32 v7, 163840, v3
    s_mul_i32 s43, s26, 10240
    s_mul_i32 s34, s31, 204800
    s_add_u32 s34, s34, s43
    s_add_u32 s34, s34, 15736832
    s_add_u32 s35, s34, 4096
    s_lshl_b32 s40, s32, 2
    s_lshl_b32 s41, s33, 1
    s_add_u32 s40, s40, s41
    s_lshl_b32 s42, s40, 6
    s_add_u32 s42, s42, 10485760
    s_mul_i32 s40, s40, 40960
    s_add_u32 s40, s40, s43
    s_add_u32 s40, s40, 10493952
    s_mul_i32 s43, s26, 19456
    s_add_u32 s43, s43, 86016
    s_mov_b32 s44, s18
    s_and_b32 s45, s19, 0xffff
    s_mov_b32 s46, 2621440
    s_mov_b32 s47, 0x00020000
    v_and_b32 v8, 15, v2
    v_lshrrev_b32 v9, 4, v2
    v_lshlrev_b32 v10, 2, v8
    v_add_u32 v11, s43, v3
    s_waitcnt vmcnt(0)
    s_barrier
    s_cmp_lg_u32 s24, 0
    s_cbranch_scc1 P3_W0
    s_lshl_b32 s60, s28, 6
    s_lshl_b32 s61, s25, 2
    s_add_u32 s60, s60, s61
    s_add_u32 s60, s60, 17376256
    v_mov_b32 v16, 1
    v_mov_b32 v17, 0
    s_mov_b64 exec, 1
    buffer_store_dword v16, v17, s[36:39], s60 offen sc1
    s_mov_b64 exec, -1
P3_W0:
    s_mul_i32 s63, s26, 15360
    s_cmp_eq_u32 s33, 1
    s_cbranch_scc1 P3_E1
    s_add_u32 m0, s63, 0
    s_add_u32 s69, s66, 44032
    buffer_load_dwordx4 v3, s[36:39], s69 offen lds
    s_add_u32 m0, s63, 1024
    s_add_u32 s69, s66, 84992
    buffer_load_dwordx4 v3, s[36:39], s69 offen lds
    s_add_u32 m0, s63, 2048
    s_add_u32 s69, s66, 125952
    buffer_load_dwordx4 v3, s[36:39], s69 offen lds
    s_add_u32 m0, s63, 3072
    s_add_u32 s69, s66, 166912
    buffer_load_dwordx4 v3, s[36:39], s69 offen lds
    s_add_u32 m0, s63, 4096
    s_add_u32 s69, s66, 4096
    buffer_load_dwordx4 v3, s[36:39], s69 offen lds
    s_add_u32 m0, s63, 5120
    s_add_u32 s69, s66, 45056
    buffer_load_dwordx4 v3, s[36:39], s69 offen lds
    s_add_u32 m0, s63, 6144
    s_add_u32 s69, s66, 86016
    buffer_load_dwordx4 v3, s[36:39], s69 offen lds
    s_add_u32 m0, s63, 7168
    s_add_u32 s69, s66, 126976
    buffer_load_dwordx4 v3, s[36:39], s69 offen lds
    s_branch P3_E2
P3_E1:
    s_add_u32 m0, s63, 8192
    s_add_u32 s69, s66, 167936
    buffer_load_dwordx4 v3, s[36:39], s69 offen lds
    s_add_u32 m0, s63, 9216
    s_add_u32 s69, s66, 5120
    buffer_load_dwordx4 v3, s[36:39], s69 offen lds
    s_add_u32 m0, s63, 10240
    s_add_u32 s69, s66, 46080
    buffer_load_dwordx4 v3, s[36:39], s69 offen lds
    s_add_u32 m0, s63, 11264
    s_add_u32 s69, s66, 87040
    buffer_load_dwordx4 v3, s[36:39], s69 offen lds
    s_add_u32 m0, s63, 12288
    s_add_u32 s69, s66, 128000
    buffer_load_dwordx4 v3, s[36:39], s69 offen lds
    s_add_u32 m0, s63, 13312
    s_add_u32 s69, s66, 168960
    buffer_load_dwordx4 v3, s[36:39], s69 offen lds
    s_add_u32 m0, s63, 14336
    s_add_u32 s69, s66, 6144
    buffer_load_dwordx4 v3, s[36:39], s69 offen lds
P3_E2:
    v_add_u32 v1, s63, v3
    s_add_u32 s70, s66, 0
    buffer_load_dwordx4 v[56:59], v3, s[36:39], s70 offen offset:0
    s_add_u32 s71, s66, 40960
    buffer_load_dwordx4 v[60:63], v3, s[36:39], s71 offen offset:0
    s_add_u32 s72, s66, 81920
    buffer_load_dwordx4 v[64:67], v3, s[36:39], s72 offen offset:0
    s_add_u32 s73, s66, 122880
    buffer_load_dwordx4 v[68:71], v3, s[36:39], s73 offen offset:0
    s_add_u32 s74, s66, 163840
    buffer_load_dwordx4 v[72:75], v3, s[36:39], s74 offen offset:0
    buffer_load_dwordx4 v[76:79], v3, s[36:39], s70 offen offset:1024
    buffer_load_dwordx4 v[80:83], v3, s[36:39], s71 offen offset:1024
    buffer_load_dwordx4 v[84:87], v3, s[36:39], s72 offen offset:1024
    buffer_load_dwordx4 v[88:91], v3, s[36:39], s73 offen offset:1024
    buffer_load_dwordx4 v[92:95], v3, s[36:39], s74 offen offset:1024
    buffer_load_dwordx4 v[96:99], v3, s[36:39], s70 offen offset:2048
    buffer_load_dwordx4 v[100:103], v3, s[36:39], s71 offen offset:2048
    buffer_load_dwordx4 v[104:107], v3, s[36:39], s72 offen offset:2048
    buffer_load_dwordx4 v[108:111], v3, s[36:39], s73 offen offset:2048
    buffer_load_dwordx4 v[112:115], v3, s[36:39], s74 offen offset:2048
    buffer_load_dwordx4 v[116:119], v3, s[36:39], s70 offen offset:3072
P3_NOPRE:
    s_cmp_lg_u32 s24, 0
    s_cbranch_scc1 P3_W
    s_lshr_b32 s60, s32, 1
    s_lshl_b32 s60, s60, 6
    s_add_u32 s60, s60, 17376256
    s_mov_b32 s98, 0
POLL4:
    buffer_load_dword v17, v10, s[36:39], s60 offen sc1
    s_waitcnt vmcnt(0)
    v_cmp_ne_u32 vcc, 1, v17
    s_nop 1
    s_cmp_eq_u64 vcc, 0
    s_cbranch_scc1 POLL4_OK
    s_sleep 1
    s_add_u32 s98, s98, 1
    s_cmp_lt_u32 s98, 65536
    s_cbranch_scc1 POLL4
POLL4_OK:
P3_W:
    s_waitcnt vmcnt(16)
    s_barrier
    s_add_u32 s41, s40, 4096
    s_add_u32 s60, s40, 8192
    buffer_load_dwordx4 v[180:183], v3, s[36:39], s40 offen offset:0
    buffer_load_dwordx4 v[184:187], v4, s[36:39], s40 offen offset:0
    buffer_load_dwordx4 v[188:191], v3, s[36:39], s40 offen offset:1024
    buffer_load_dwordx4 v[192:195], v4, s[36:39], s40 offen offset:1024
    buffer_load_dwordx4 v[196:199], v3, s[36:39], s40 offen offset:2048
    buffer_load_dwordx4 v[200:203], v4, s[36:39], s40 offen offset:2048
    buffer_load_dwordx4 v[204:207], v3, s[36:39], s40 offen offset:3072
    buffer_load_dwordx4 v[208:211], v4, s[36:39], s40 offen offset:3072
    buffer_load_dwordx4 v[212:215], v3, s[36:39], s41 offen offset:0
    buffer_load_dwordx4 v[216:219], v4, s[36:39], s41 offen offset:0
    buffer_load_dwordx4 v[220:223], v3, s[36:39], s41 offen offset:1024
    buffer_load_dwordx4 v[224:227], v4, s[36:39], s41 offen offset:1024
    buffer_load_dwordx4 v[228:231], v3, s[36:39], s41 offen offset:2048
    buffer_load_dwordx4 v[232:235], v4, s[36:39], s41 offen offset:2048
    buffer_load_dwordx4 v[236:239], v3, s[36:39], s41 offen offset:3072
    buffer_load_dwordx4 v[240:243], v4, s[36:39], s41 offen offset:3072
    buffer_load_dword v12, v10, s[36:39], s42 offen offset:0
    buffer_load_dword v13, v10, s[36:39], s42 offen offset:64
    s_waitcnt vmcnt(16)
    v_mfma_f32_16x16x32_bf16 v[16:19], v[56:59], v[180:183], 0
    v_mfma_f32_16x16x32_bf16 v[36:39], v[56:59], v[184:187], 0
    v_mfma_f32_16x16x32_bf16 v[20:23], v[60:63], v[180:183], 0
    v_mfma_f32_16x16x32_bf16 v[40:43], v[60:63], v[184:187], 0
    v_mfma_f32_16x16x32_bf16 v[24:27], v[64:67], v[180:183], 0
    v_mfma_f32_16x16x32_bf16 v[44:47], v[64:67], v[184:187], 0
    v_mfma_f32_16x16x32_bf16 v[28:31], v[68:71], v[180:183], 0
    v_mfma_f32_16x16x32_bf16 v[48:51], v[68:71], v[184:187], 0
    v_mfma_f32_16x16x32_bf16 v[32:35], v[72:75], v[180:183], 0
    v_mfma_f32_16x16x32_bf16 v[52:55], v[72:75], v[184:187], 0
    buffer_load_dwordx4 v[180:183], v3, s[36:39], s60 offen offset:0
    buffer_load_dwordx4 v[184:187], v4, s[36:39], s60 offen offset:0
    s_waitcnt vmcnt(16)
    v_mfma_f32_16x16x32_bf16 v[16:19], v[76:79], v[188:191], v[16:19]
    v_mfma_f32_16x16x32_bf16 v[36:39], v[76:79], v[192:195], v[36:39]
    v_mfma_f32_16x16x32_bf16 v[20:23], v[80:83], v[188:191], v[20:23]
    v_mfma_f32_16x16x32_bf16 v[40:43], v[80:83], v[192:195], v[40:43]
    v_mfma_f32_16x16x32_bf16 v[24:27], v[84:87], v[188:191], v[24:27]
    v_mfma_f32_16x16x32_bf16 v[44:47], v[84:87], v[192:195], v[44:47]
    v_mfma_f32_16x16x32_bf16 v[28:31], v[88:91], v[188:191], v[28:31]
    v_mfma_f32_16x16x32_bf16 v[48:51], v[88:91], v[192:195], v[48:51]
    v_mfma_f32_16x16x32_bf16 v[32:35], v[92:95], v[188:191], v[32:35]
    v_mfma_f32_16x16x32_bf16 v[52:55], v[92:95], v[192:195], v[52:55]
    buffer_load_dwordx4 v[188:191], v3, s[36:39], s60 offen offset:1024
    buffer_load_dwordx4 v[192:195], v4, s[36:39], s60 offen offset:1024
    ds_read_b128 v[124:127], v1 offset:0
    ds_read_b128 v[128:131], v1 offset:1024
    ds_read_b128 v[132:135], v1 offset:2048
    ds_read_b128 v[136:139], v1 offset:3072
    s_waitcnt vmcnt(16)
    v_mfma_f32_16x16x32_bf16 v[16:19], v[96:99], v[196:199], v[16:19]
    v_mfma_f32_16x16x32_bf16 v[36:39], v[96:99], v[200:203], v[36:39]
    v_mfma_f32_16x16x32_bf16 v[20:23], v[100:103], v[196:199], v[20:23]
    v_mfma_f32_16x16x32_bf16 v[40:43], v[100:103], v[200:203], v[40:43]
    v_mfma_f32_16x16x32_bf16 v[24:27], v[104:107], v[196:199], v[24:27]
    v_mfma_f32_16x16x32_bf16 v[44:47], v[104:107], v[200:203], v[44:47]
    v_mfma_f32_16x16x32_bf16 v[28:31], v[108:111], v[196:199], v[28:31]
    v_mfma_f32_16x16x32_bf16 v[48:51], v[108:111], v[200:203], v[48:51]
    v_mfma_f32_16x16x32_bf16 v[32:35], v[112:115], v[196:199], v[32:35]
    v_mfma_f32_16x16x32_bf16 v[52:55], v[112:115], v[200:203], v[52:55]
    ds_read_b128 v[140:143], v1 offset:4096
    ds_read_b128 v[144:147], v1 offset:5120
    ds_read_b128 v[148:151], v1 offset:6144
    ds_read_b128 v[152:155], v1 offset:7168
    ds_read_b128 v[156:159], v1 offset:8192
    s_waitcnt vmcnt(14)
    s_waitcnt lgkmcnt(5)
    v_mfma_f32_16x16x32_bf16 v[16:19], v[116:119], v[204:207], v[16:19]
    v_mfma_f32_16x16x32_bf16 v[36:39], v[116:119], v[208:211], v[36:39]
    v_mfma_f32_16x16x32_bf16 v[20:23], v[124:127], v[204:207], v[20:23]
    v_mfma_f32_16x16x32_bf16 v[40:43], v[124:127], v[208:211], v[40:43]
    v_mfma_f32_16x16x32_bf16 v[24:27], v[128:131], v[204:207], v[24:27]
    v_mfma_f32_16x16x32_bf16 v[44:47], v[128:131], v[208:211], v[44:47]
    v_mfma_f32_16x16x32_bf16 v[28:31], v[132:135], v[204:207], v[28:31]
    v_mfma_f32_16x16x32_bf16 v[48:51], v[132:135], v[208:211], v[48:51]
    v_mfma_f32_16x16x32_bf16 v[32:35], v[136:139], v[204:207], v[32:35]
    v_mfma_f32_16x16x32_bf16 v[52:55], v[136:139], v[208:211], v[52:55]
    ds_read_b128 v[160:163], v1 offset:9216
    ds_read_b128 v[164:167], v1 offset:10240
    ds_read_b128 v[168:171], v1 offset:11264
    ds_read_b128 v[172:175], v1 offset:12288
    ds_read_b128 v[176:179], v1 offset:13312
    s_waitcnt vmcnt(12)
    s_waitcnt lgkmcnt(5)
    v_mfma_f32_16x16x32_bf16 v[16:19], v[140:143], v[212:215], v[16:19]
    v_mfma_f32_16x16x32_bf16 v[36:39], v[140:143], v[216:219], v[36:39]
    v_mfma_f32_16x16x32_bf16 v[20:23], v[144:147], v[212:215], v[20:23]
    v_mfma_f32_16x16x32_bf16 v[40:43], v[144:147], v[216:219], v[40:43]
    v_mfma_f32_16x16x32_bf16 v[24:27], v[148:151], v[212:215], v[24:27]
    v_mfma_f32_16x16x32_bf16 v[44:47], v[148:151], v[216:219], v[44:47]
    v_mfma_f32_16x16x32_bf16 v[28:31], v[152:155], v[212:215], v[28:31]
    v_mfma_f32_16x16x32_bf16 v[48:51], v[152:155], v[216:219], v[48:51]
    v_mfma_f32_16x16x32_bf16 v[32:35], v[156:159], v[212:215], v[32:35]
    v_mfma_f32_16x16x32_bf16 v[52:55], v[156:159], v[216:219], v[52:55]
    ds_read_b128 v[120:123], v1 offset:14336
    ds_read_b128 v[124:127], v11 offset:0
    ds_read_b128 v[128:131], v11 offset:1024
    ds_read_b128 v[132:135], v11 offset:2048
    ds_read_b128 v[136:139], v11 offset:3072
    s_waitcnt vmcnt(10)
    s_waitcnt lgkmcnt(5)
    v_mfma_f32_16x16x32_bf16 v[16:19], v[160:163], v[220:223], v[16:19]
    v_mfma_f32_16x16x32_bf16 v[36:39], v[160:163], v[224:227], v[36:39]
    v_mfma_f32_16x16x32_bf16 v[20:23], v[164:167], v[220:223], v[20:23]
    v_mfma_f32_16x16x32_bf16 v[40:43], v[164:167], v[224:227], v[40:43]
    v_mfma_f32_16x16x32_bf16 v[24:27], v[168:171], v[220:223], v[24:27]
    v_mfma_f32_16x16x32_bf16 v[44:47], v[168:171], v[224:227], v[44:47]
    v_mfma_f32_16x16x32_bf16 v[28:31], v[172:175], v[220:223], v[28:31]
    v_mfma_f32_16x16x32_bf16 v[48:51], v[172:175], v[224:227], v[48:51]
    v_mfma_f32_16x16x32_bf16 v[32:35], v[176:179], v[220:223], v[32:35]
    v_mfma_f32_16x16x32_bf16 v[52:55], v[176:179], v[224:227], v[52:55]
    ds_read_b128 v[140:143], v11 offset:4096
    ds_read_b128 v[144:147], v11 offset:5120
    ds_read_b128 v[148:151], v11 offset:6144
    ds_read_b128 v[152:155], v11 offset:7168
    ds_read_b128 v[156:159], v11 offset:8192
    s_waitcnt vmcnt(8)
    s_waitcnt lgkmcnt(5)
    v_mfma_f32_16x16x32_bf16 v[16:19], v[120:123], v[228:231], v[16:19]
    v_mfma_f32_16x16x32_bf16 v[36:39], v[120:123], v[232:235], v[36:39]
    v_mfma_f32_16x16x32_bf16 v[20:23], v[124:127], v[228:231], v[20:23]
    v_mfma_f32_16x16x32_bf16 v[40:43], v[124:127], v[232:235], v[40:43]
    v_mfma_f32_16x16x32_bf16 v[24:27], v[128:131], v[228:231], v[24:27]
    v_mfma_f32_16x16x32_bf16 v[44:47], v[128:131], v[232:235], v[44:47]
    v_mfma_f32_16x16x32_bf16 v[28:31], v[132:135], v[228:231], v[28:31]
    v_mfma_f32_16x16x32_bf16 v[48:51], v[132:135], v[232:235], v[48:51]
    v_mfma_f32_16x16x32_bf16 v[32:35], v[136:139], v[228:231], v[32:35]
    v_mfma_f32_16x16x32_bf16 v[52:55], v[136:139], v[232:235], v[52:55]
    ds_read_b128 v[160:163], v11 offset:9216
    ds_read_b128 v[164:167], v11 offset:10240
    ds_read_b128 v[168:171], v11 offset:11264
    ds_read_b128 v[172:175], v11 offset:12288
    ds_read_b128 v[176:179], v11 offset:13312
    s_waitcnt vmcnt(6)
    s_waitcnt lgkmcnt(5)
    v_mfma_f32_16x16x32_bf16 v[16:19], v[140:143], v[236:239], v[16:19]
    v_mfma_f32_16x16x32_bf16 v[36:39], v[140:143], v[240:243], v[36:39]
    v_mfma_f32_16x16x32_bf16 v[20:23], v[144:147], v[236:239], v[20:23]
    v_mfma_f32_16x16x32_bf16 v[40:43], v[144:147], v[240:243], v[40:43]
    v_mfma_f32_16x16x32_bf16 v[24:27], v[148:151], v[236:239], v[24:27]
    v_mfma_f32_16x16x32_bf16 v[44:47], v[148:151], v[240:243], v[44:47]
    v_mfma_f32_16x16x32_bf16 v[28:31], v[152:155], v[236:239], v[28:31]
    v_mfma_f32_16x16x32_bf16 v[48:51], v[152:155], v[240:243], v[48:51]
    v_mfma_f32_16x16x32_bf16 v[32:35], v[156:159], v[236:239], v[32:35]
    v_mfma_f32_16x16x32_bf16 v[52:55], v[156:159], v[240:243], v[52:55]
    ds_read_b128 v[120:123], v11 offset:14336
    ds_read_b128 v[124:127], v11 offset:15360
    ds_read_b128 v[128:131], v11 offset:16384
    ds_read_b128 v[132:135], v11 offset:17408
    ds_read_b128 v[136:139], v11 offset:18432
    s_waitcnt vmcnt(2)
    s_waitcnt lgkmcnt(5)
    v_mfma_f32_16x16x32_bf16 v[16:19], v[160:163], v[180:183], v[16:19]
    v_mfma_f32_16x16x32_bf16 v[36:39], v[160:163], v[184:187], v[36:39]
    v_mfma_f32_16x16x32_bf16 v[20:23], v[164:167], v[180:183], v[20:23]
    v_mfma_f32_16x16x32_bf16 v[40:43], v[164:167], v[184:187], v[40:43]
    v_mfma_f32_16x16x32_bf16 v[24:27], v[168:171], v[180:183], v[24:27]
    v_mfma_f32_16x16x32_bf16 v[44:47], v[168:171], v[184:187], v[44:47]
    v_mfma_f32_16x16x32_bf16 v[28:31], v[172:175], v[180:183], v[28:31]
    v_mfma_f32_16x16x32_bf16 v[48:51], v[172:175], v[184:187], v[48:51]
    v_mfma_f32_16x16x32_bf16 v[32:35], v[176:179], v[180:183], v[32:35]
    v_mfma_f32_16x16x32_bf16 v[52:55], v[176:179], v[184:187], v[52:55]
    s_waitcnt vmcnt(0)
    s_waitcnt lgkmcnt(0)
    v_mfma_f32_16x16x32_bf16 v[16:19], v[120:123], v[188:191], v[16:19]
    v_mfma_f32_16x16x32_bf16 v[36:39], v[120:123], v[192:195], v[36:39]
    v_mfma_f32_16x16x32_bf16 v[20:23], v[124:127], v[188:191], v[20:23]
    v_mfma_f32_16x16x32_bf16 v[40:43], v[124:127], v[192:195], v[40:43]
    v_mfma_f32_16x16x32_bf16 v[24:27], v[128:131], v[188:191], v[24:27]
    v_mfma_f32_16x16x32_bf16 v[44:47], v[128:131], v[192:195], v[44:47]
    v_mfma_f32_16x16x32_bf16 v[28:31], v[132:135], v[188:191], v[28:31]
    v_mfma_f32_16x16x32_bf16 v[48:51], v[132:135], v[192:195], v[48:51]
    v_mfma_f32_16x16x32_bf16 v[32:35], v[136:139], v[188:191], v[32:35]
    v_mfma_f32_16x16x32_bf16 v[52:55], v[136:139], v[192:195], v[52:55]
    s_cmp_lt_u32 s26, 2
    s_cbranch_scc1 P3_NOINV
    v_sub_f32 v12, 1.0, v12
    v_sub_f32 v13, 1.0, v13
P3_NOINV:
    v_mov_b32 v244, v12
    v_mov_b32 v245, v12
    v_mov_b32 v246, v13
    v_mov_b32 v247, v13
    s_mul_i32 s60, s33, 30720
    s_add_u32 s60, s60, 0
    v_add_u32 v11, s60, v3
    v_pk_mul_f32 v[16:17], v[16:17], v[244:245]
    v_pk_mul_f32 v[18:19], v[18:19], v[244:245]
    v_pk_mul_f32 v[20:21], v[20:21], v[244:245]
    v_pk_mul_f32 v[22:23], v[22:23], v[244:245]
    v_pk_mul_f32 v[24:25], v[24:25], v[244:245]
    v_pk_mul_f32 v[26:27], v[26:27], v[244:245]
    v_pk_mul_f32 v[28:29], v[28:29], v[244:245]
    v_pk_mul_f32 v[30:31], v[30:31], v[244:245]
    v_pk_mul_f32 v[32:33], v[32:33], v[244:245]
    v_pk_mul_f32 v[34:35], v[34:35], v[244:245]
    v_pk_mul_f32 v[36:37], v[36:37], v[246:247]
    v_pk_mul_f32 v[38:39], v[38:39], v[246:247]
    v_pk_mul_f32 v[40:41], v[40:41], v[246:247]
    v_pk_mul_f32 v[42:43], v[42:43], v[246:247]
    v_pk_mul_f32 v[44:45], v[44:45], v[246:247]
    v_pk_mul_f32 v[46:47], v[46:47], v[246:247]
    v_pk_mul_f32 v[48:49], v[48:49], v[246:247]
    v_pk_mul_f32 v[50:51], v[50:51], v[246:247]
    v_pk_mul_f32 v[52:53], v[52:53], v[246:247]
    v_pk_mul_f32 v[54:55], v[54:55], v[246:247]
    s_barrier
    s_cmp_lg_u32 s26, 0
    s_cbranch_scc1 P3_Q0
    ds_write_b128 v11, v[20:23] offset:5120
    ds_write_b128 v11, v[24:27] offset:7168
    ds_write_b128 v11, v[28:31] offset:9216
    ds_write_b128 v11, v[36:39] offset:17408
    ds_write_b128 v11, v[40:43] offset:19456
    ds_write_b128 v11, v[44:47] offset:21504
    ds_write_b128 v11, v[52:55] offset:29696
    s_waitcnt lgkmcnt(0)
    s_barrier
    ds_read_b128 v[60:63], v11 offset:0
    ds_read_b128 v[64:67], v11 offset:1024
    ds_read_b128 v[68:71], v11 offset:2048
    ds_read_b128 v[72:75], v11 offset:12288
    ds_read_b128 v[76:79], v11 offset:13312
    ds_read_b128 v[80:83], v11 offset:14336
    ds_read_b128 v[84:87], v11 offset:24576
    ds_read_b128 v[88:91], v11 offset:25600
    ds_read_b128 v[92:95], v11 offset:26624
    v_mul_u32_u24 v1, 1280, v8
    v_lshl_add_u32 v1, v9, 3, v1
    s_lshl_b32 s60, s32, 6
    s_lshl_b32 s61, s33, 5
    s_add_u32 s60, s60, s61
    s_mul_i32 s60, s60, 1280
    s_mul_i32 s61, s31, 160
    s_add_u32 s60, s60, s61
    s_add_u32 s61, s60, 20480
    s_waitcnt lgkmcnt(0)
    v_pk_add_f32 v[16:17], v[16:17], v[60:61]
    v_pk_add_f32 v[18:19], v[18:19], v[62:63]
    v_pk_add_f32 v[16:17], v[16:17], v[64:65]
    v_pk_add_f32 v[18:19], v[18:19], v[66:67]
    v_pk_add_f32 v[16:17], v[16:17], v[68:69]
    v_pk_add_f32 v[18:19], v[18:19], v[70:71]
    v_cvt_pk_bf16_f32 v100, v16, v17
    v_cvt_pk_bf16_f32 v101, v18, v19
    buffer_store_dwordx2 v[100:101], v1, s[44:47], s60 offen offset:0
    v_pk_add_f32 v[32:33], v[32:33], v[72:73]
    v_pk_add_f32 v[34:35], v[34:35], v[74:75]
    v_pk_add_f32 v[32:33], v[32:33], v[76:77]
    v_pk_add_f32 v[34:35], v[34:35], v[78:79]
    v_pk_add_f32 v[32:33], v[32:33], v[80:81]
    v_pk_add_f32 v[34:35], v[34:35], v[82:83]
    v_cvt_pk_bf16_f32 v102, v32, v33
    v_cvt_pk_bf16_f32 v103, v34, v35
    buffer_store_dwordx2 v[102:103], v1, s[44:47], s60 offen offset:128
    v_pk_add_f32 v[48:49], v[48:49], v[84:85]
    v_pk_add_f32 v[50:51], v[50:51], v[86:87]
    v_pk_add_f32 v[48:49], v[48:49], v[88:89]
    v_pk_add_f32 v[50:51], v[50:51], v[90:91]
    v_pk_add_f32 v[48:49], v[48:49], v[92:93]
    v_pk_add_f32 v[50:51], v[50:51], v[94:95]
    v_cvt_pk_bf16_f32 v104, v48, v49
    v_cvt_pk_bf16_f32 v105, v50, v51
    buffer_store_dwordx2 v[104:105], v1, s[44:47], s61 offen offset:96
    s_branch P3_END
P3_Q0:
    s_cmp_lg_u32 s26, 1
    s_cbranch_scc1 P3_Q1
    ds_write_b128 v11, v[16:19] offset:0
    ds_write_b128 v11, v[24:27] offset:8192
    ds_write_b128 v11, v[28:31] offset:10240
    ds_write_b128 v11, v[32:35] offset:12288
    ds_write_b128 v11, v[40:43] offset:20480
    ds_write_b128 v11, v[44:47] offset:22528
    ds_write_b128 v11, v[48:51] offset:24576
    s_waitcnt lgkmcnt(0)
    s_barrier
    ds_read_b128 v[60:63], v11 offset:3072
    ds_read_b128 v[64:67], v11 offset:4096
    ds_read_b128 v[68:71], v11 offset:5120
    ds_read_b128 v[72:75], v11 offset:15360
    ds_read_b128 v[76:79], v11 offset:16384
    ds_read_b128 v[80:83], v11 offset:17408
    ds_read_b128 v[84:87], v11 offset:27648
    ds_read_b128 v[88:91], v11 offset:28672
    ds_read_b128 v[92:95], v11 offset:29696
    v_mul_u32_u24 v1, 1280, v8
    v_lshl_add_u32 v1, v9, 3, v1
    s_lshl_b32 s60, s32, 6
    s_lshl_b32 s61, s33, 5
    s_add_u32 s60, s60, s61
    s_mul_i32 s60, s60, 1280
    s_mul_i32 s61, s31, 160
    s_add_u32 s60, s60, s61
    s_add_u32 s61, s60, 20480
    s_waitcnt lgkmcnt(0)
    v_pk_add_f32 v[20:21], v[20:21], v[60:61]
    v_pk_add_f32 v[22:23], v[22:23], v[62:63]
    v_pk_add_f32 v[20:21], v[20:21], v[64:65]
    v_pk_add_f32 v[22:23], v[22:23], v[66:67]
    v_pk_add_f32 v[20:21], v[20:21], v[68:69]
    v_pk_add_f32 v[22:23], v[22:23], v[70:71]
    v_cvt_pk_bf16_f32 v100, v20, v21
    v_cvt_pk_bf16_f32 v101, v22, v23
    buffer_store_dwordx2 v[100:101], v1, s[44:47], s60 offen offset:32
    v_pk_add_f32 v[36:37], v[36:37], v[72:73]
    v_pk_add_f32 v[38:39], v[38:39], v[74:75]
    v_pk_add_f32 v[36:37], v[36:37], v[76:77]
    v_pk_add_f32 v[38:39], v[38:39], v[78:79]
    v_pk_add_f32 v[36:37], v[36:37], v[80:81]
    v_pk_add_f32 v[38:39], v[38:39], v[82:83]
    v_cvt_pk_bf16_f32 v102, v36, v37
    v_cvt_pk_bf16_f32 v103, v38, v39
    buffer_store_dwordx2 v[102:103], v1, s[44:47], s61 offen offset:0
    v_pk_add_f32 v[52:53], v[52:53], v[84:85]
    v_pk_add_f32 v[54:55], v[54:55], v[86:87]
    v_pk_add_f32 v[52:53], v[52:53], v[88:89]
    v_pk_add_f32 v[54:55], v[54:55], v[90:91]
    v_pk_add_f32 v[52:53], v[52:53], v[92:93]
    v_pk_add_f32 v[54:55], v[54:55], v[94:95]
    v_cvt_pk_bf16_f32 v104, v52, v53
    v_cvt_pk_bf16_f32 v105, v54, v55
    buffer_store_dwordx2 v[104:105], v1, s[44:47], s61 offen offset:128
    s_branch P3_END
P3_Q1:
    s_cmp_lg_u32 s26, 2
    s_cbranch_scc1 P3_Q2
    ds_write_b128 v11, v[16:19] offset:1024
    ds_write_b128 v11, v[20:23] offset:3072
    ds_write_b128 v11, v[28:31] offset:11264
    ds_write_b128 v11, v[32:35] offset:13312
    ds_write_b128 v11, v[36:39] offset:15360
    ds_write_b128 v11, v[44:47] offset:23552
    ds_write_b128 v11, v[48:51] offset:25600
    ds_write_b128 v11, v[52:55] offset:27648
    s_waitcnt lgkmcnt(0)
    s_barrier
    ds_read_b128 v[60:63], v11 offset:6144
    ds_read_b128 v[64:67], v11 offset:7168
    ds_read_b128 v[68:71], v11 offset:8192
    ds_read_b128 v[72:75], v11 offset:18432
    ds_read_b128 v[76:79], v11 offset:19456
    ds_read_b128 v[80:83], v11 offset:20480
    v_mul_u32_u24 v1, 1280, v8
    v_lshl_add_u32 v1, v9, 3, v1
    s_lshl_b32 s60, s32, 6
    s_lshl_b32 s61, s33, 5
    s_add_u32 s60, s60, s61
    s_mul_i32 s60, s60, 1280
    s_mul_i32 s61, s31, 160
    s_add_u32 s60, s60, s61
    s_add_u32 s61, s60, 20480
    s_waitcnt lgkmcnt(0)
    v_pk_add_f32 v[24:25], v[24:25], v[60:61]
    v_pk_add_f32 v[26:27], v[26:27], v[62:63]
    v_pk_add_f32 v[24:25], v[24:25], v[64:65]
    v_pk_add_f32 v[26:27], v[26:27], v[66:67]
    v_pk_add_f32 v[24:25], v[24:25], v[68:69]
    v_pk_add_f32 v[26:27], v[26:27], v[70:71]
    v_cvt_pk_bf16_f32 v100, v24, v25
    v_cvt_pk_bf16_f32 v101, v26, v27
    buffer_store_dwordx2 v[100:101], v1, s[44:47], s60 offen offset:64
    v_pk_add_f32 v[40:41], v[40:41], v[72:73]
    v_pk_add_f32 v[42:43], v[42:43], v[74:75]
    v_pk_add_f32 v[40:41], v[40:41], v[76:77]
    v_pk_add_f32 v[42:43], v[42:43], v[78:79]
    v_pk_add_f32 v[40:41], v[40:41], v[80:81]
    v_pk_add_f32 v[42:43], v[42:43], v[82:83]
    v_cvt_pk_bf16_f32 v102, v40, v41
    v_cvt_pk_bf16_f32 v103, v42, v43
    buffer_store_dwordx2 v[102:103], v1, s[44:47], s61 offen offset:32
    s_branch P3_END
P3_Q2:
    s_cmp_lg_u32 s26, 3
    s_cbranch_scc1 P3_Q3
    ds_write_b128 v11, v[16:19] offset:2048
    ds_write_b128 v11, v[20:23] offset:4096
    ds_write_b128 v11, v[24:27] offset:6144
    ds_write_b128 v11, v[32:35] offset:14336
    ds_write_b128 v11, v[36:39] offset:16384
    ds_write_b128 v11, v[40:43] offset:18432
    ds_write_b128 v11, v[48:51] offset:26624
    ds_write_b128 v11, v[52:55] offset:28672
    s_waitcnt lgkmcnt(0)
    s_barrier
    ds_read_b128 v[60:63], v11 offset:9216
    ds_read_b128 v[64:67], v11 offset:10240
    ds_read_b128 v[68:71], v11 offset:11264
    ds_read_b128 v[72:75], v11 offset:21504
    ds_read_b128 v[76:79], v11 offset:22528
    ds_read_b128 v[80:83], v11 offset:23552
    v_mul_u32_u24 v1, 1280, v8
    v_lshl_add_u32 v1, v9, 3, v1
    s_lshl_b32 s60, s32, 6
    s_lshl_b32 s61, s33, 5
    s_add_u32 s60, s60, s61
    s_mul_i32 s60, s60, 1280
    s_mul_i32 s61, s31, 160
    s_add_u32 s60, s60, s61
    s_add_u32 s61, s60, 20480
    s_waitcnt lgkmcnt(0)
    v_pk_add_f32 v[28:29], v[28:29], v[60:61]
    v_pk_add_f32 v[30:31], v[30:31], v[62:63]
    v_pk_add_f32 v[28:29], v[28:29], v[64:65]
    v_pk_add_f32 v[30:31], v[30:31], v[66:67]
    v_pk_add_f32 v[28:29], v[28:29], v[68:69]
    v_pk_add_f32 v[30:31], v[30:31], v[70:71]
    v_cvt_pk_bf16_f32 v100, v28, v29
    v_cvt_pk_bf16_f32 v101, v30, v31
    buffer_store_dwordx2 v[100:101], v1, s[44:47], s60 offen offset:96
    v_pk_add_f32 v[44:45], v[44:45], v[72:73]
    v_pk_add_f32 v[46:47], v[46:47], v[74:75]
    v_pk_add_f32 v[44:45], v[44:45], v[76:77]
    v_pk_add_f32 v[46:47], v[46:47], v[78:79]
    v_pk_add_f32 v[44:45], v[44:45], v[80:81]
    v_pk_add_f32 v[46:47], v[46:47], v[82:83]
    v_cvt_pk_bf16_f32 v102, v44, v45
    v_cvt_pk_bf16_f32 v103, v46, v47
    buffer_store_dwordx2 v[102:103], v1, s[44:47], s61 offen offset:64
    s_branch P3_END
P3_Q3:
P3_END:
K_END:
    s_endpgm
KCODE_END:
.section .rodata,"a"
.p2align 6
.amdhsa_kernel gated_mix__sliding_block__linear_attn_block__prompt_kernel
  .amdhsa_next_free_vgpr 256
  .amdhsa_next_free_sgpr 102
  .amdhsa_accum_offset 256
  .amdhsa_group_segment_fixed_size 0
  .amdhsa_kernarg_size 80
  .amdhsa_user_sgpr_count 2
  .amdhsa_user_sgpr_kernarg_segment_ptr 1
  .amdhsa_system_sgpr_workgroup_id_x 1
.end_amdhsa_kernel
```
